```python
import torch

def _softmax(x, axis=-1):
    return torch.softmax(x, dim=axis)
def _gelu(x):
    return torch.nn.functional.gelu(x, approximate="tanh")
def _silu(x):
    return torch.nn.functional.silu(x)
def _sigmoid(x):
    return torch.sigmoid(x)
def _layernorm(x, axis=-1, eps=1e-5):
    m = x.mean(dim=axis, keepdim=True)
    v = x.var(dim=axis, keepdim=True, unbiased=False)
    return (x - m) / torch.sqrt(v + eps)
def _scatter_add(tgt, idx, src, axis=0):
    return tgt.clone().index_add_(axis, idx, src)
def _segment_sum(src, seg, n):
    out = torch.zeros((n,) + src.shape[1:], dtype=src.dtype)
    return out.index_add_(0, seg, src)
def _pad(x, pw):
    flat = tuple(v for pair in reversed(pw) for v in pair)
    return torch.nn.functional.pad(x, flat)

kernel_name = 'sequential_preLN__linear_kernel_hedgehog__dense_activation_squared_relu__prompt'

def setup_inputs():

    _w = (lambda a: (lambda t: t.to(torch.bfloat16) if t.is_floating_point() else t)(torch.as_tensor(a)))
    def _A_setup():
        B, S, D, H = 1, 2048, 512, 32
        Dh = D // H
        return {
            "x": _w((lambda *s: torch.randn(*s, dtype=torch.bfloat16) * 0.05)(B, S, D)),
            "wqkv": _w((lambda *s: torch.randn(*s, dtype=torch.bfloat16) * 0.2)(D, 3 * D)),
            "w_phi": _w((lambda *s: torch.randn(*s, dtype=torch.bfloat16) * 0.2)(H, Dh, Dh) * (Dh ** -0.5)),
            "wo": _w((lambda *s: torch.randn(*s, dtype=torch.bfloat16) * 0.05)(D, D)),
        }
    _A_in = _A_setup()

    def _B_setup():
        B, S, D, F = 1, 2048, 512, 1376
        return {
            "x": _w((lambda *s: torch.randn(*s, dtype=torch.bfloat16) * 0.05)(B, S, D)),
            "w1": _w((lambda *s: torch.randn(*s, dtype=torch.bfloat16) * 0.05)(D, F)),
            "b1": _w((lambda *s: torch.randn(*s, dtype=torch.bfloat16) * 0.4)(F)),
            "w2": _w((lambda *s: torch.randn(*s, dtype=torch.bfloat16) * 0.05)(F, D)),
            "b2": _w((lambda *s: torch.randn(*s, dtype=torch.bfloat16) * 1.6)(D)),
        }
    _B_in = _B_setup()

    return {
        "A_x": _A_in["x"],
        "A_wqkv": _A_in["wqkv"],
        "A_w_phi": _A_in["w_phi"],
        "A_wo": _A_in["wo"],
        "B_x": _B_in["x"],
        "B_w1": _B_in["w1"],
        "B_b1": _B_in["b1"],
        "B_w2": _B_in["w2"],
        "B_b2": _B_in["b2"],
    }

def reference(A_x, A_wqkv, A_w_phi, A_wo, B_x, B_w1, B_b1, B_w2, B_b2):
    def _A_ref(x, wqkv, w_phi, wo):
        B, S, D = x.shape
        H = 32; Dh = D // H
        qkv = (lambda x, *d: x.permute(*d))((x @ wqkv).reshape(B, S, 3, H, Dh), 2, 0, 3, 1, 4)
        q, k, v = qkv[0], qkv[1], qkv[2]
        pq = torch.einsum("bhsd,hdf->bhsf", q, w_phi)
        pk = torch.einsum("bhsd,hdf->bhsf", k, w_phi)
        phi_q = torch.concatenate([_softmax(pq, axis=-1), _softmax(-pq, axis=-1)], axis=-1)
        phi_k = torch.concatenate([_softmax(pk, axis=-1), _softmax(-pk, axis=-1)], axis=-1)
        kv = torch.einsum("bhsf,bhsd->bhfd", phi_k, v)
        z  = torch.einsum("bhsf->bhf", phi_k)
        num = torch.einsum("bhqf,bhfd->bhqd", phi_q, kv)
        den = torch.einsum("bhqf,bhf->bhq", phi_q, z)[..., None] + 1e-6
        o = num / den
        return (lambda x, *d: x.permute(*d))(o, 0, 2, 1, 3).reshape(B, S, D) @ wo

    def _B_ref(x, w1, b1, w2, b2):
        h = torch.einsum("bsd,df->bsf", x, w1) + b1
        zero = torch.zeros_like(h)
        r = torch.where(h > zero, h, zero)
        h = r * r
        out = torch.einsum("bsf,fd->bsd", h, w2) + b2
        return out

    x = A_x
    h = x + _A_ref(_layernorm(x, axis=-1), A_wqkv, A_w_phi, A_wo)
    h2 = h + _B_ref(_layernorm(h, axis=-1), B_w1, B_b1, B_w2, B_b2)
    return h2
```

```asm
; @launch kernel=mega_kernel grid=(256,1,1) block=(768,1,1) lds=163840
.amdgcn_target "amdgcn-amd-amdhsa--gfx950"
.text
.globl mega_kernel
.p2align 8
.type mega_kernel,@function
mega_kernel:
    s_cmp_ge_u32 s2, 256
    s_cbranch_scc1 mega_exit
    s_load_dwordx2 s[4:5], s[0:1], 0
    s_load_dwordx2 s[8:9], s[0:1], 8
    s_load_dwordx2 s[12:13], s[0:1], 16
    s_load_dwordx2 s[16:17], s[0:1], 88
    s_load_dwordx2 s[40:41], s[0:1], 24
    s_load_dwordx2 s[44:45], s[0:1], 40
    s_load_dwordx2 s[48:49], s[0:1], 56
    s_load_dwordx2 s[52:53], s[0:1], 48
    s_load_dwordx2 s[56:57], s[0:1], 64
    s_load_dwordx2 s[60:61], s[0:1], 72
    s_load_dwordx2 s[64:65], s[0:1], 80
    v_and_b32 v1, 63, v0
    v_lshrrev_b32 v6, 6, v0
    v_lshrrev_b32 v2, 4, v1
    v_and_b32 v3, 15, v1
    v_readfirstlane_b32 s20, v6
    v_bfe_u32 v4, v1, 2, 2
    v_and_b32 v5, 3, v1
    v_lshlrev_b32 v6, 4, v1
    s_add_u32 s21, s20, 8
    s_sub_u32 s20, s20, 4
    s_cselect_b32 s20, s21, s20
    s_mov_b32 s3, 0
    s_and_b32 s30, s2, 7
    s_lshr_b32 s31, s2, 3
    s_lshr_b32 s21, s30, 1
    s_lshl_b32 s21, s21, 2
    s_and_b32 s22, s31, 3
    s_add_u32 s33, s21, s22
    s_and_b32 s21, s30, 1
    s_lshl_b32 s21, s21, 3
    s_lshr_b32 s22, s31, 2
    s_add_u32 s34, s21, s22
    s_xor_b32 s34, s34, 4
    s_lshl_b32 s21, s33, 7
    s_lshl_b32 s22, s34, 6
    s_lshl_b32 s39, s33, 1
    s_add_u32 s39, s39, s34
    s_lshl_b32 s39, s39, 1
    s_waitcnt lgkmcnt(0)
    s_and_b32 s5, s5, 0xffff
    s_mov_b32 s6, 0x200000
    s_mov_b32 s7, 0x00020000
    s_and_b32 s9, s9, 0xffff
    s_mov_b32 s10, 0x180000
    s_mov_b32 s11, 0x00020000
    s_and_b32 s13, s13, 0xffff
    s_mov_b32 s14, 0x4000
    s_mov_b32 s15, 0x00020000
    s_and_b32 s17, s17, 0xffff
    s_mov_b32 s18, 0x1000000
    s_mov_b32 s19, 0x00020000
    s_cmp_ge_u32 s20, 10
    s_cbranch_scc1 prod_a
    s_cmp_ge_u32 s20, 8
    s_cbranch_scc1 prod_w
    s_lshl_b32 s23, s20, 4
    s_add_u32 s24, s21, s23
    s_xor_b32 s37, s24, 16
    s_and_b32 s36, s20, 1
    s_and_b32 s30, s2, 1
    s_or_b32 s30, s30, s20
    s_cmp_lg_u32 s30, 0
    s_cbranch_scc1 k1_nlt
    s_lshr_b32 s30, s2, 3
    s_mul_i32 s30, s30, 49152
    v_min_u32 v15, 47, v1
    v_lshlrev_b32 v15, 10, v15
    buffer_load_dword v156, v15, s[8:11], s30 offen offset:384
k1_nlt:
    s_lshl_b32 s31, s34, 10
    s_lshl_b32 s27, s36, 9
    s_add_u32 s31, s31, s27
    s_lshl_b32 s30, s24, 12
    s_add_u32 s99, s30, s31
    s_xor_b32 s29, s99, 0x10000
    v_lshlrev_b32 v165, 3, v1
    v_mov_b32 v28, -1
    v_mov_b32 v29, -1
    v_mov_b32 v30, -1
    v_mov_b32 v31, -1
    s_lshl_b32 s30, s33, 5
    s_lshl_b32 s31, s34, 1
    s_add_u32 s30, s30, s31
    s_lshr_b32 s31, s20, 2
    s_add_u32 s30, s30, s31
    s_mul_i32 s30, s30, 1152
    s_add_u32 s30, s30, 0x800000
    s_and_b32 s31, s20, 3
    s_lshl_b32 s27, s31, 9
    s_lshl_b32 s28, s31, 6
    s_add_u32 s28, s28, 896
    s_cmp_lt_u32 s31, 2
    s_cselect_b32 s27, s27, s28
    s_add_u32 s98, s30, s27
    v_lshlrev_b32 v164, 4, v2
    s_mov_b32 s96, 0x00010001
    s_mov_b32 s97, 0x00010001
    s_and_b32 s30, s2, 7
    s_lshl_b32 s30, s30, 8
    s_add_u32 s30, s30, 0x980000
    s_lshr_b32 s31, s2, 3
    s_lshl_b32 s27, s20, 5
    s_add_u32 s27, s27, s31
    s_add_u32 s0, s30, s27
    s_and_b32 s27, s31, 3
    s_lshl_b32 s27, s27, 6
    s_lshr_b32 s28, s31, 2
    s_lshl_b32 s28, s28, 3
    s_add_u32 s27, s27, s28
    s_add_u32 s27, s27, s20
    s_add_u32 s27, s27, 2048
    s_add_u32 s1, s30, s27
    s_and_b32 s27, s31, 1
    s_lshl_b32 s27, s27, 7
    s_and_b32 s28, s31, 30
    s_add_u32 s27, s27, s28
    s_lshr_b32 s28, s20, 1
    s_lshl_b32 s28, s28, 5
    s_add_u32 s27, s27, s28
    s_add_u32 s27, s27, s36
    s_add_u32 s27, s27, 4096
    s_add_u32 s39, s30, s27
    s_and_b32 s41, s41, 0xffff
    s_mov_b32 s42, 0x80000
    s_mov_b32 s43, 0x00020000
    s_and_b32 s45, s45, 0xffff
    s_mov_b32 s46, 0x158000
    s_mov_b32 s47, 0x00020000
    s_and_b32 s49, s49, 0xffff
    s_mov_b32 s50, 0x158000
    s_mov_b32 s51, 0x00020000
    s_and_b32 s53, s53, 0xffff
    s_mov_b32 s54, 0xac0
    s_mov_b32 s55, 0x00020000
    s_and_b32 s57, s57, 0xffff
    s_mov_b32 s58, 0x400
    s_mov_b32 s59, 0x00020000
    s_and_b32 s61, s61, 0xffff
    s_mov_b32 s62, 0x200000
    s_mov_b32 s63, 0x00020000
    s_and_b32 s65, s65, 0xffff
    s_mov_b32 s66, 0x100
    s_mov_b32 s67, 0x00020000
    v_lshrrev_b32 v157, 1, v1
    v_lshlrev_b32 v157, 7, v157
    v_lshlrev_b32 v24, 2, v2
    v_sub_u32 v24, v3, v24
    v_mov_b32 v26, 0x3f80
    v_mov_b32 v27, 0x3f800000
    v_cmp_eq_u32 vcc, 0, v24
    s_nop 1
    v_cndmask_b32 v20, 0, v26, vcc
    v_cmp_eq_u32 vcc, 1, v24
    s_nop 1
    v_cndmask_b32 v21, 0, v27, vcc
    v_or_b32 v20, v20, v21
    v_cmp_eq_u32 vcc, 2, v24
    s_nop 1
    v_cndmask_b32 v21, 0, v26, vcc
    v_cmp_eq_u32 vcc, 3, v24
    s_nop 1
    v_cndmask_b32 v25, 0, v27, vcc
    v_or_b32 v21, v21, v25
    v_lshl_add_u32 v22, v2, 2, v4
    v_lshlrev_b32 v22, 5, v22
    v_lshl_add_u32 v22, v5, 3, v22
    s_lshl_b32 s30, s36, 9
    s_add_u32 s30, s30, 0x27000
    v_add_u32 v22, s30, v22
    v_lshl_add_u32 v8, v2, 3, v4
    v_lshlrev_b32 v8, 6, v8
    v_lshl_add_u32 v8, v5, 3, v8
    v_and_b32 v15, 1, v2
    v_lshlrev_b32 v15, 5, v15
    s_sub_u32 s26, s20, 6
    s_cmp_lt_u32 s20, 6
    s_cselect_b32 s26, s20, s26
    s_lshr_b32 s27, s26, 1
    s_lshl_b32 s27, s27, 11
    s_lshl_b32 s28, s36, 5
    v_xor_b32 v15, s28, v15
    v_add_u32 v8, v8, v15
    v_add_u32 v11, s27, v8
    s_lshl_b32 s35, s20, 10
    v_lshlrev_b32 v15, 1, v4
    v_mov_b32 v14, 0x78
    v_lshrrev_b32 v15, v15, v14
    v_and_b32 v15, 3, v15
    v_xor_b32 v15, v15, v2
    v_lshlrev_b32 v15, 4, v15
    v_lshl_add_u32 v15, v3, 6, v15
    v_add_u32 v40, s35, v15
    v_xor_b32 v43, 0x400, v40
    v_add_u32 v9, 0xe000, v8
    v_add_u32 v12, 0xe000, v11
    v_add_u32 v41, 0xe000, v40
    v_add_u32 v44, 0xe000, v43
    v_add_u32 v10, 0x1c000, v8
    v_add_u32 v13, 0x1c000, v11
    v_add_u32 v42, 0x1c000, v40
    v_add_u32 v45, 0x1c000, v43
    v_mov_b32 v16, 0x3f803f80
    v_mov_b32 v17, 0x3f803f80
    v_mov_b32 v18, 0x3f803f80
    v_mov_b32 v19, 0x3f803f80
    s_barrier
    ds_read_b128 v[48:51], v40 offset:6144
    ds_read_b64_tr_b16 v[56:57], v8 offset:0
    ds_read_b64_tr_b16 v[58:59], v8 offset:256
    ds_read_b64_tr_b16 v[60:61], v8 offset:2048
    ds_read_b64_tr_b16 v[62:63], v8 offset:2304
    ds_read_b128 v[52:55], v43 offset:6144
    ds_read_b64_tr_b16 v[64:65], v8 offset:4096
    ds_read_b64_tr_b16 v[66:67], v8 offset:4352
    ds_read_b64_tr_b16 v[68:69], v11 offset:0
    ds_read_b64_tr_b16 v[70:71], v11 offset:256
    s_barrier
    ds_read_b128 v[72:75], v40 offset:20480
    ds_read_b64_tr_b16 v[80:81], v8 offset:14336
    ds_read_b64_tr_b16 v[82:83], v8 offset:14592
    ds_read_b64_tr_b16 v[84:85], v8 offset:16384
    ds_read_b64_tr_b16 v[86:87], v8 offset:16640
    ds_read_b128 v[76:79], v43 offset:20480
    ds_read_b64_tr_b16 v[88:89], v8 offset:18432
    ds_read_b64_tr_b16 v[90:91], v8 offset:18688
    ds_read_b64_tr_b16 v[92:93], v11 offset:14336
    ds_read_b64_tr_b16 v[94:95], v11 offset:14592
    s_waitcnt lgkmcnt(10)
    v_mfma_f32_16x16x32_bf16 v[96:99], v[56:59], v[48:51], 0
    s_barrier
    ds_read_b128 v[132:135], v40 offset:34816
    ds_read_b64_tr_b16 v[140:141], v8 offset:28672
    v_mfma_f32_16x16x32_bf16 v[100:103], v[60:63], v[48:51], 0
    ds_read_b64_tr_b16 v[142:143], v8 offset:28928
    ds_read_b64_tr_b16 v[144:145], v8 offset:30720
    v_mfma_f32_16x16x32_bf16 v[104:107], v[64:67], v[48:51], 0
    ds_read_b64_tr_b16 v[146:147], v8 offset:30976
    ds_read_b128 v[136:139], v43 offset:34816
    v_mfma_f32_16x16x32_bf16 v[108:111], v[56:59], v[52:55], 0
    ds_read_b64_tr_b16 v[148:149], v8 offset:32768
    ds_read_b64_tr_b16 v[150:151], v8 offset:33024
    v_mfma_f32_16x16x32_bf16 v[112:115], v[60:63], v[52:55], 0
    ds_read_b64_tr_b16 v[152:153], v11 offset:28672
    ds_read_b64_tr_b16 v[154:155], v11 offset:28928
    v_mfma_f32_16x16x32_bf16 v[116:119], v[64:67], v[52:55], 0
    v_mfma_f32_16x16x32_bf16 v[128:131], v[68:71], v[16:19], 0
    v_mfma_f32_16x16x32_bf16 v[120:123], v[16:19], v[48:51], 0
    v_mfma_f32_16x16x32_bf16 v[124:127], v[48:51], v[48:51], 0
    s_xor_b32 s29, s99, 0x10000
    buffer_store_dwordx2 v[28:29], v165, s[16:19], s99 offen sc1
    buffer_store_dwordx2 v[28:29], v165, s[16:19], s29 offen sc1
    s_bitcmp1_b32 s20, 1
    s_cbranch_scc1 Lz1
    buffer_store_dwordx2 v[28:29], v165, s[16:19], s98 offen sc1
    s_branch Le2
Lz1:
    s_mov_b64 exec, s[96:97]
    buffer_store_dwordx4 v[28:31], v164, s[16:19], s98 offen sc1
    s_mov_b64 exec, -1
Le2:
    s_lshr_b32 s30, s2, 3
    s_or_b32 s30, s30, s20
    s_cmp_lg_u32 s30, 0
    s_cbranch_scc1 k1_nfc
    v_lshlrev_b32 v23, 11, v2
    v_lshl_add_u32 v23, v3, 4, v23
    v_mov_b32 v24, 0
    v_mov_b32 v25, 0
    v_mov_b32 v26, 0
    v_mov_b32 v27, 0
    s_mov_b32 s30, -1
    s_mov_b32 s31, 0xffff
    s_mov_b64 exec, s[30:31]
    buffer_store_dwordx4 v[24:27], v23, s[16:19], s0 offen sc1
    s_mov_b64 exec, -1
k1_nfc:
    s_waitcnt lgkmcnt(10)
    v_mfma_f32_16x16x32_bf16 v[96:99], v[80:83], v[72:75], v[96:99]
    ds_read_b128 v[48:51], v40 offset:49152
    ds_read_b64_tr_b16 v[56:57], v8 offset:43008
    v_mfma_f32_16x16x32_bf16 v[100:103], v[84:87], v[72:75], v[100:103]
    ds_read_b64_tr_b16 v[58:59], v8 offset:43264
    ds_read_b64_tr_b16 v[60:61], v8 offset:45056
    v_mfma_f32_16x16x32_bf16 v[104:107], v[88:91], v[72:75], v[104:107]
    ds_read_b64_tr_b16 v[62:63], v8 offset:45312
    ds_read_b128 v[52:55], v43 offset:49152
    v_mfma_f32_16x16x32_bf16 v[108:111], v[80:83], v[76:79], v[108:111]
    ds_read_b64_tr_b16 v[64:65], v8 offset:47104
    ds_read_b64_tr_b16 v[66:67], v8 offset:47360
    v_mfma_f32_16x16x32_bf16 v[112:115], v[84:87], v[76:79], v[112:115]
    ds_read_b64_tr_b16 v[68:69], v11 offset:43008
    ds_read_b64_tr_b16 v[70:71], v11 offset:43264
    v_mfma_f32_16x16x32_bf16 v[116:119], v[88:91], v[76:79], v[116:119]
    v_mfma_f32_16x16x32_bf16 v[128:131], v[92:95], v[16:19], v[128:131]
    v_mfma_f32_16x16x32_bf16 v[120:123], v[16:19], v[72:75], v[120:123]
    v_mfma_f32_16x16x32_bf16 v[124:127], v[72:75], v[72:75], v[124:127]
    s_waitcnt lgkmcnt(10)
    v_mfma_f32_16x16x32_bf16 v[96:99], v[140:143], v[132:135], v[96:99]
    s_barrier
    ds_read_b128 v[72:75], v41 offset:6144
    ds_read_b64_tr_b16 v[80:81], v9 offset:0
    v_mfma_f32_16x16x32_bf16 v[100:103], v[144:147], v[132:135], v[100:103]
    ds_read_b64_tr_b16 v[82:83], v9 offset:256
    ds_read_b64_tr_b16 v[84:85], v9 offset:2048
    v_mfma_f32_16x16x32_bf16 v[104:107], v[148:151], v[132:135], v[104:107]
    ds_read_b64_tr_b16 v[86:87], v9 offset:2304
    ds_read_b128 v[76:79], v44 offset:6144
    v_mfma_f32_16x16x32_bf16 v[108:111], v[140:143], v[136:139], v[108:111]
    ds_read_b64_tr_b16 v[88:89], v9 offset:4096
    ds_read_b64_tr_b16 v[90:91], v9 offset:4352
    v_mfma_f32_16x16x32_bf16 v[112:115], v[144:147], v[136:139], v[112:115]
    ds_read_b64_tr_b16 v[92:93], v12 offset:0
    ds_read_b64_tr_b16 v[94:95], v12 offset:256
    v_mfma_f32_16x16x32_bf16 v[116:119], v[148:151], v[136:139], v[116:119]
    v_mfma_f32_16x16x32_bf16 v[128:131], v[152:155], v[16:19], v[128:131]
    v_mfma_f32_16x16x32_bf16 v[120:123], v[16:19], v[132:135], v[120:123]
    v_mfma_f32_16x16x32_bf16 v[124:127], v[132:135], v[132:135], v[124:127]
    s_waitcnt lgkmcnt(10)
    v_mfma_f32_16x16x32_bf16 v[96:99], v[56:59], v[48:51], v[96:99]
    ds_read_b128 v[132:135], v41 offset:20480
    ds_read_b64_tr_b16 v[140:141], v9 offset:14336
    v_mfma_f32_16x16x32_bf16 v[100:103], v[60:63], v[48:51], v[100:103]
    ds_read_b64_tr_b16 v[142:143], v9 offset:14592
    ds_read_b64_tr_b16 v[144:145], v9 offset:16384
    v_mfma_f32_16x16x32_bf16 v[104:107], v[64:67], v[48:51], v[104:107]
    ds_read_b64_tr_b16 v[146:147], v9 offset:16640
    ds_read_b128 v[136:139], v44 offset:20480
    v_mfma_f32_16x16x32_bf16 v[108:111], v[56:59], v[52:55], v[108:111]
    ds_read_b64_tr_b16 v[148:149], v9 offset:18432
    ds_read_b64_tr_b16 v[150:151], v9 offset:18688
    v_mfma_f32_16x16x32_bf16 v[112:115], v[60:63], v[52:55], v[112:115]
    ds_read_b64_tr_b16 v[152:153], v12 offset:14336
    ds_read_b64_tr_b16 v[154:155], v12 offset:14592
    v_mfma_f32_16x16x32_bf16 v[116:119], v[64:67], v[52:55], v[116:119]
    v_mfma_f32_16x16x32_bf16 v[128:131], v[68:71], v[16:19], v[128:131]
    v_mfma_f32_16x16x32_bf16 v[120:123], v[16:19], v[48:51], v[120:123]
    v_mfma_f32_16x16x32_bf16 v[124:127], v[48:51], v[48:51], v[124:127]
    s_waitcnt lgkmcnt(10)
    v_mfma_f32_16x16x32_bf16 v[96:99], v[80:83], v[72:75], v[96:99]
    s_waitcnt vmcnt(0)
    s_barrier
    ds_read_b128 v[48:51], v41 offset:34816
    ds_read_b64_tr_b16 v[56:57], v9 offset:28672
    v_mfma_f32_16x16x32_bf16 v[100:103], v[84:87], v[72:75], v[100:103]
    ds_read_b64_tr_b16 v[58:59], v9 offset:28928
    ds_read_b64_tr_b16 v[60:61], v9 offset:30720
    v_mfma_f32_16x16x32_bf16 v[104:107], v[88:91], v[72:75], v[104:107]
    ds_read_b64_tr_b16 v[62:63], v9 offset:30976
    ds_read_b128 v[52:55], v44 offset:34816
    v_mfma_f32_16x16x32_bf16 v[108:111], v[80:83], v[76:79], v[108:111]
    ds_read_b64_tr_b16 v[64:65], v9 offset:32768
    ds_read_b64_tr_b16 v[66:67], v9 offset:33024
    v_mfma_f32_16x16x32_bf16 v[112:115], v[84:87], v[76:79], v[112:115]
    ds_read_b64_tr_b16 v[68:69], v12 offset:28672
    ds_read_b64_tr_b16 v[70:71], v12 offset:28928
    v_mfma_f32_16x16x32_bf16 v[116:119], v[88:91], v[76:79], v[116:119]
    v_mfma_f32_16x16x32_bf16 v[128:131], v[92:95], v[16:19], v[128:131]
    v_mfma_f32_16x16x32_bf16 v[120:123], v[16:19], v[72:75], v[120:123]
    v_mfma_f32_16x16x32_bf16 v[124:127], v[72:75], v[72:75], v[124:127]
    s_cmp_lg_u32 s20, 0
    s_cbranch_scc1 c_nrdy
    s_getreg_b32 s30, hwreg(HW_REG_XCC_ID, 0, 4)
    s_and_b32 s31, s2, 7
    s_lshl_b32 s31, s31, 5
    s_mul_i32 s29, s30, s30
    s_lshl_b32 s29, s29, 18
    s_lshl_b32 s30, s30, 8
    s_add_u32 s30, s30, s29
    s_add_u32 s30, s30, 1
    v_mov_b32 v23, s30
    v_mov_b32 v24, 0
    s_mov_b64 exec, 1
    buffer_atomic_add v23, v24, s[64:67], s31 offen
    s_mov_b64 exec, -1
c_nrdy:
    s_waitcnt lgkmcnt(10)
    v_mfma_f32_16x16x32_bf16 v[96:99], v[140:143], v[132:135], v[96:99]
    ds_read_b128 v[72:75], v41 offset:49152
    ds_read_b64_tr_b16 v[80:81], v9 offset:43008
    v_mfma_f32_16x16x32_bf16 v[100:103], v[144:147], v[132:135], v[100:103]
    ds_read_b64_tr_b16 v[82:83], v9 offset:43264
    ds_read_b64_tr_b16 v[84:85], v9 offset:45056
    v_mfma_f32_16x16x32_bf16 v[104:107], v[148:151], v[132:135], v[104:107]
    ds_read_b64_tr_b16 v[86:87], v9 offset:45312
    ds_read_b128 v[76:79], v44 offset:49152
    v_mfma_f32_16x16x32_bf16 v[108:111], v[140:143], v[136:139], v[108:111]
    ds_read_b64_tr_b16 v[88:89], v9 offset:47104
    ds_read_b64_tr_b16 v[90:91], v9 offset:47360
    v_mfma_f32_16x16x32_bf16 v[112:115], v[144:147], v[136:139], v[112:115]
    ds_read_b64_tr_b16 v[92:93], v12 offset:43008
    ds_read_b64_tr_b16 v[94:95], v12 offset:43264
    v_mfma_f32_16x16x32_bf16 v[116:119], v[148:151], v[136:139], v[116:119]
    v_mfma_f32_16x16x32_bf16 v[128:131], v[152:155], v[16:19], v[128:131]
    v_mfma_f32_16x16x32_bf16 v[120:123], v[16:19], v[132:135], v[120:123]
    v_mfma_f32_16x16x32_bf16 v[124:127], v[132:135], v[132:135], v[124:127]
    s_waitcnt lgkmcnt(10)
    v_mfma_f32_16x16x32_bf16 v[96:99], v[56:59], v[48:51], v[96:99]
    s_barrier
    ds_read_b128 v[132:135], v42 offset:6144
    ds_read_b64_tr_b16 v[140:141], v10 offset:0
    v_mfma_f32_16x16x32_bf16 v[100:103], v[60:63], v[48:51], v[100:103]
    ds_read_b64_tr_b16 v[142:143], v10 offset:256
    ds_read_b64_tr_b16 v[144:145], v10 offset:2048
    v_mfma_f32_16x16x32_bf16 v[104:107], v[64:67], v[48:51], v[104:107]
    ds_read_b64_tr_b16 v[146:147], v10 offset:2304
    ds_read_b128 v[136:139], v45 offset:6144
    v_mfma_f32_16x16x32_bf16 v[108:111], v[56:59], v[52:55], v[108:111]
    ds_read_b64_tr_b16 v[148:149], v10 offset:4096
    ds_read_b64_tr_b16 v[150:151], v10 offset:4352
    v_mfma_f32_16x16x32_bf16 v[112:115], v[60:63], v[52:55], v[112:115]
    ds_read_b64_tr_b16 v[152:153], v13 offset:0
    ds_read_b64_tr_b16 v[154:155], v13 offset:256
    v_mfma_f32_16x16x32_bf16 v[116:119], v[64:67], v[52:55], v[116:119]
    v_mfma_f32_16x16x32_bf16 v[128:131], v[68:71], v[16:19], v[128:131]
    v_mfma_f32_16x16x32_bf16 v[120:123], v[16:19], v[48:51], v[120:123]
    v_mfma_f32_16x16x32_bf16 v[124:127], v[48:51], v[48:51], v[124:127]
    s_cmp_lg_u32 s20, 6
    s_cbranch_scc1 Lt3
    s_lshr_b32 s30, s2, 3
    s_mul_i32 s30, s30, 16384
    s_add_u32 s30, s30, 0
    buffer_load_dword v156, v157, s[40:43], s30 offen
Lt3:
    s_cmp_lg_u32 s20, 1
    s_cbranch_scc1 Lt4
    s_lshr_b32 s30, s2, 3
    s_mul_i32 s30, s30, 16384
    s_add_u32 s30, s30, 4096
    buffer_load_dword v156, v157, s[40:43], s30 offen
Lt4:
    s_waitcnt lgkmcnt(10)
    v_mfma_f32_16x16x32_bf16 v[96:99], v[80:83], v[72:75], v[96:99]
    ds_read_b128 v[48:51], v42 offset:20480
    ds_read_b64_tr_b16 v[56:57], v10 offset:14336
    v_mfma_f32_16x16x32_bf16 v[100:103], v[84:87], v[72:75], v[100:103]
    ds_read_b64_tr_b16 v[58:59], v10 offset:14592
    ds_read_b64_tr_b16 v[60:61], v10 offset:16384
    v_mfma_f32_16x16x32_bf16 v[104:107], v[88:91], v[72:75], v[104:107]
    ds_read_b64_tr_b16 v[62:63], v10 offset:16640
    ds_read_b128 v[52:55], v45 offset:20480
    v_mfma_f32_16x16x32_bf16 v[108:111], v[80:83], v[76:79], v[108:111]
    ds_read_b64_tr_b16 v[64:65], v10 offset:18432
    ds_read_b64_tr_b16 v[66:67], v10 offset:18688
    v_mfma_f32_16x16x32_bf16 v[112:115], v[84:87], v[76:79], v[112:115]
    ds_read_b64_tr_b16 v[68:69], v13 offset:14336
    ds_read_b64_tr_b16 v[70:71], v13 offset:14592
    v_mfma_f32_16x16x32_bf16 v[116:119], v[88:91], v[76:79], v[116:119]
    v_mfma_f32_16x16x32_bf16 v[128:131], v[92:95], v[16:19], v[128:131]
    v_mfma_f32_16x16x32_bf16 v[120:123], v[16:19], v[72:75], v[120:123]
    v_mfma_f32_16x16x32_bf16 v[124:127], v[72:75], v[72:75], v[124:127]
    s_cmp_lg_u32 s20, 7
    s_cbranch_scc1 Lt5
    s_lshr_b32 s30, s2, 3
    s_mul_i32 s30, s30, 16384
    s_add_u32 s30, s30, 8192
    buffer_load_dword v156, v157, s[40:43], s30 offen
Lt5:
    s_cmp_lg_u32 s20, 2
    s_cbranch_scc1 Lt6
    s_lshr_b32 s30, s2, 3
    s_mul_i32 s30, s30, 16384
    s_add_u32 s30, s30, 12288
    buffer_load_dword v156, v157, s[40:43], s30 offen
Lt6:
    s_waitcnt lgkmcnt(10)
    v_mfma_f32_16x16x32_bf16 v[96:99], v[140:143], v[132:135], v[96:99]
    s_barrier
    ds_read_b128 v[72:75], v42 offset:34816
    ds_read_b64_tr_b16 v[80:81], v10 offset:28672
    v_mfma_f32_16x16x32_bf16 v[100:103], v[144:147], v[132:135], v[100:103]
    ds_read_b64_tr_b16 v[82:83], v10 offset:28928
    ds_read_b64_tr_b16 v[84:85], v10 offset:30720
    v_mfma_f32_16x16x32_bf16 v[104:107], v[148:151], v[132:135], v[104:107]
    ds_read_b64_tr_b16 v[86:87], v10 offset:30976
    ds_read_b128 v[76:79], v45 offset:34816
    v_mfma_f32_16x16x32_bf16 v[108:111], v[140:143], v[136:139], v[108:111]
    ds_read_b64_tr_b16 v[88:89], v10 offset:32768
    ds_read_b64_tr_b16 v[90:91], v10 offset:33024
    v_mfma_f32_16x16x32_bf16 v[112:115], v[144:147], v[136:139], v[112:115]
    ds_read_b64_tr_b16 v[92:93], v13 offset:28672
    ds_read_b64_tr_b16 v[94:95], v13 offset:28928
    v_mfma_f32_16x16x32_bf16 v[116:119], v[148:151], v[136:139], v[116:119]
    v_mfma_f32_16x16x32_bf16 v[128:131], v[152:155], v[16:19], v[128:131]
    v_mfma_f32_16x16x32_bf16 v[120:123], v[16:19], v[132:135], v[120:123]
    v_mfma_f32_16x16x32_bf16 v[124:127], v[132:135], v[132:135], v[124:127]
    s_cmp_lg_u32 s20, 0
    s_cbranch_scc1 Lt7
    s_lshr_b32 s30, s2, 3
    s_and_b32 s31, s2, 7
    s_lshl_b32 s31, s31, 5
    s_add_u32 s30, s30, s31
    s_mul_i32 s30, s30, 8192
    s_add_u32 s30, s30, 0
    buffer_load_dword v156, v157, s[4:7], s30 offen
Lt7:
    s_cmp_lg_u32 s20, 3
    s_cbranch_scc1 Lt8
    s_lshr_b32 s30, s2, 3
    s_and_b32 s31, s2, 7
    s_lshl_b32 s31, s31, 5
    s_add_u32 s30, s30, s31
    s_mul_i32 s30, s30, 8192
    s_add_u32 s30, s30, 4096
    buffer_load_dword v156, v157, s[4:7], s30 offen
Lt8:
    s_waitcnt lgkmcnt(10)
    v_mfma_f32_16x16x32_bf16 v[96:99], v[56:59], v[48:51], v[96:99]
    ds_read_b128 v[132:135], v40 offset:6144
    ds_read_b64_tr_b16 v[140:141], v8 offset:0
    v_mfma_f32_16x16x32_bf16 v[100:103], v[60:63], v[48:51], v[100:103]
    ds_read_b64_tr_b16 v[142:143], v8 offset:256
    ds_read_b64_tr_b16 v[144:145], v8 offset:2048
    v_mfma_f32_16x16x32_bf16 v[104:107], v[64:67], v[48:51], v[104:107]
    ds_read_b64_tr_b16 v[146:147], v8 offset:2304
    ds_read_b128 v[136:139], v43 offset:6144
    v_mfma_f32_16x16x32_bf16 v[108:111], v[56:59], v[52:55], v[108:111]
    ds_read_b64_tr_b16 v[148:149], v8 offset:4096
    ds_read_b64_tr_b16 v[150:151], v8 offset:4352
    v_mfma_f32_16x16x32_bf16 v[112:115], v[60:63], v[52:55], v[112:115]
    ds_read_b64_tr_b16 v[152:153], v11 offset:0
    ds_read_b64_tr_b16 v[154:155], v11 offset:256
    v_mfma_f32_16x16x32_bf16 v[116:119], v[64:67], v[52:55], v[116:119]
    v_mfma_f32_16x16x32_bf16 v[128:131], v[68:71], v[16:19], v[128:131]
    v_mfma_f32_16x16x32_bf16 v[120:123], v[16:19], v[48:51], v[120:123]
    v_mfma_f32_16x16x32_bf16 v[124:127], v[48:51], v[48:51], v[124:127]
    s_cmp_lg_u32 s20, 1
    s_cbranch_scc1 Lt9
    s_lshr_b32 s30, s2, 3
    s_and_b32 s31, s2, 7
    s_lshl_b32 s31, s31, 5
    s_add_u32 s30, s30, s31
    s_and_b32 s31, s30, 1
    s_mul_i32 s31, s31, 9216
    s_lshr_b32 s30, s30, 1
    s_lshl_b32 s30, s30, 16
    s_add_u32 s30, s30, s31
    s_add_u32 s30, s30, 44032
    s_add_u32 s30, s30, 0
    buffer_load_dword v156, v157, s[16:19], s30 offen sc1
Lt9:
    s_cmp_lg_u32 s20, 4
    s_cbranch_scc1 Lt10
    s_lshr_b32 s30, s2, 3
    s_and_b32 s31, s2, 7
    s_lshl_b32 s31, s31, 5
    s_add_u32 s30, s30, s31
    s_and_b32 s31, s30, 1
    s_mul_i32 s31, s31, 9216
    s_lshr_b32 s30, s30, 1
    s_lshl_b32 s30, s30, 16
    s_add_u32 s30, s30, s31
    s_add_u32 s30, s30, 44032
    s_add_u32 s30, s30, 4096
    buffer_load_dword v156, v157, s[16:19], s30 offen sc1
Lt10:
    s_cmp_lg_u32 s20, 7
    s_cbranch_scc1 Lt11
    s_lshr_b32 s30, s2, 3
    s_and_b32 s31, s2, 7
    s_lshl_b32 s31, s31, 5
    s_add_u32 s30, s30, s31
    s_and_b32 s31, s30, 1
    s_mul_i32 s31, s31, 9216
    s_lshr_b32 s30, s30, 1
    s_lshl_b32 s30, s30, 16
    s_add_u32 s30, s30, s31
    s_add_u32 s30, s30, 44032
    s_add_u32 s30, s30, 5120
    buffer_load_dword v156, v157, s[16:19], s30 offen sc1
Lt11:
    s_waitcnt lgkmcnt(10)
    v_mfma_f32_16x16x32_bf16 v[96:99], v[80:83], v[72:75], v[96:99]
    s_barrier
    ds_read_b128 v[48:51], v40 offset:20480
    ds_read_b64_tr_b16 v[56:57], v8 offset:14336
    v_mfma_f32_16x16x32_bf16 v[100:103], v[84:87], v[72:75], v[100:103]
    ds_read_b64_tr_b16 v[58:59], v8 offset:14592
    ds_read_b64_tr_b16 v[60:61], v8 offset:16384
    v_mfma_f32_16x16x32_bf16 v[104:107], v[88:91], v[72:75], v[104:107]
    ds_read_b64_tr_b16 v[62:63], v8 offset:16640
    ds_read_b128 v[52:55], v43 offset:20480
    v_mfma_f32_16x16x32_bf16 v[108:111], v[80:83], v[76:79], v[108:111]
    ds_read_b64_tr_b16 v[64:65], v8 offset:18432
    ds_read_b64_tr_b16 v[66:67], v8 offset:18688
    v_mfma_f32_16x16x32_bf16 v[112:115], v[84:87], v[76:79], v[112:115]
    ds_read_b64_tr_b16 v[68:69], v11 offset:14336
    ds_read_b64_tr_b16 v[70:71], v11 offset:14592
    v_mfma_f32_16x16x32_bf16 v[116:119], v[88:91], v[76:79], v[116:119]
    v_mfma_f32_16x16x32_bf16 v[128:131], v[92:95], v[16:19], v[128:131]
    v_mfma_f32_16x16x32_bf16 v[120:123], v[16:19], v[72:75], v[120:123]
    v_mfma_f32_16x16x32_bf16 v[124:127], v[72:75], v[72:75], v[124:127]
    s_cmp_lg_u32 s20, 2
    s_cbranch_scc1 Lt12
    s_lshr_b32 s30, s2, 3
    s_mul_i32 s30, s30, 44032
    s_add_u32 s30, s30, 0
    buffer_load_dword v156, v157, s[44:47], s30 offen
Lt12:
    s_cmp_lg_u32 s20, 5
    s_cbranch_scc1 Lt13
    s_lshr_b32 s30, s2, 3
    s_mul_i32 s30, s30, 44032
    s_add_u32 s30, s30, 4096
    buffer_load_dword v156, v157, s[44:47], s30 offen
Lt13:
    s_cmp_lg_u32 s20, 0
    s_cbranch_scc1 Lt14
    s_lshr_b32 s30, s2, 3
    s_mul_i32 s30, s30, 44032
    s_add_u32 s30, s30, 8192
    buffer_load_dword v156, v157, s[44:47], s30 offen
Lt14:
    s_waitcnt lgkmcnt(10)
    v_mfma_f32_16x16x32_bf16 v[96:99], v[140:143], v[132:135], v[96:99]
    ds_read_b128 v[72:75], v40 offset:34816
    ds_read_b64_tr_b16 v[80:81], v8 offset:28672
    v_mfma_f32_16x16x32_bf16 v[100:103], v[144:147], v[132:135], v[100:103]
    ds_read_b64_tr_b16 v[82:83], v8 offset:28928
    ds_read_b64_tr_b16 v[84:85], v8 offset:30720
    v_mfma_f32_16x16x32_bf16 v[104:107], v[148:151], v[132:135], v[104:107]
    ds_read_b64_tr_b16 v[86:87], v8 offset:30976
    ds_read_b128 v[76:79], v43 offset:34816
    v_mfma_f32_16x16x32_bf16 v[108:111], v[140:143], v[136:139], v[108:111]
    ds_read_b64_tr_b16 v[88:89], v8 offset:32768
    ds_read_b64_tr_b16 v[90:91], v8 offset:33024
    v_mfma_f32_16x16x32_bf16 v[112:115], v[144:147], v[136:139], v[112:115]
    ds_read_b64_tr_b16 v[92:93], v11 offset:28672
    ds_read_b64_tr_b16 v[94:95], v11 offset:28928
    v_mfma_f32_16x16x32_bf16 v[116:119], v[148:151], v[136:139], v[116:119]
    v_mfma_f32_16x16x32_bf16 v[128:131], v[152:155], v[16:19], v[128:131]
    v_mfma_f32_16x16x32_bf16 v[120:123], v[16:19], v[132:135], v[120:123]
    v_mfma_f32_16x16x32_bf16 v[124:127], v[132:135], v[132:135], v[124:127]
    s_cmp_lg_u32 s20, 3
    s_cbranch_scc1 Lt15
    s_lshr_b32 s30, s2, 3
    s_mul_i32 s30, s30, 44032
    s_add_u32 s30, s30, 12288
    buffer_load_dword v156, v157, s[44:47], s30 offen
Lt15:
    s_cmp_lg_u32 s20, 6
    s_cbranch_scc1 Lt16
    s_lshr_b32 s30, s2, 3
    s_mul_i32 s30, s30, 44032
    s_add_u32 s30, s30, 16384
    buffer_load_dword v156, v157, s[44:47], s30 offen
Lt16:
    s_cmp_lg_u32 s20, 1
    s_cbranch_scc1 Lt17
    s_lshr_b32 s30, s2, 3
    s_mul_i32 s30, s30, 44032
    s_add_u32 s30, s30, 20480
    buffer_load_dword v156, v157, s[44:47], s30 offen
Lt17:
    s_waitcnt lgkmcnt(10)
    v_mfma_f32_16x16x32_bf16 v[96:99], v[56:59], v[48:51], v[96:99]
    s_barrier
    ds_read_b128 v[132:135], v40 offset:49152
    ds_read_b64_tr_b16 v[140:141], v8 offset:43008
    v_mfma_f32_16x16x32_bf16 v[100:103], v[60:63], v[48:51], v[100:103]
    ds_read_b64_tr_b16 v[142:143], v8 offset:43264
    ds_read_b64_tr_b16 v[144:145], v8 offset:45056
    v_mfma_f32_16x16x32_bf16 v[104:107], v[64:67], v[48:51], v[104:107]
    ds_read_b64_tr_b16 v[146:147], v8 offset:45312
    ds_read_b128 v[136:139], v43 offset:49152
    v_mfma_f32_16x16x32_bf16 v[108:111], v[56:59], v[52:55], v[108:111]
    ds_read_b64_tr_b16 v[148:149], v8 offset:47104
    ds_read_b64_tr_b16 v[150:151], v8 offset:47360
    v_mfma_f32_16x16x32_bf16 v[112:115], v[60:63], v[52:55], v[112:115]
    ds_read_b64_tr_b16 v[152:153], v11 offset:43008
    ds_read_b64_tr_b16 v[154:155], v11 offset:43264
    v_mfma_f32_16x16x32_bf16 v[116:119], v[64:67], v[52:55], v[116:119]
    v_mfma_f32_16x16x32_bf16 v[128:131], v[68:71], v[16:19], v[128:131]
    v_mfma_f32_16x16x32_bf16 v[120:123], v[16:19], v[48:51], v[120:123]
    v_mfma_f32_16x16x32_bf16 v[124:127], v[48:51], v[48:51], v[124:127]
    s_cmp_lg_u32 s20, 4
    s_cbranch_scc1 Lt18
    s_lshr_b32 s30, s2, 3
    s_mul_i32 s30, s30, 44032
    s_add_u32 s30, s30, 24576
    buffer_load_dword v156, v157, s[44:47], s30 offen
Lt18:
    s_cmp_lg_u32 s20, 7
    s_cbranch_scc1 Lt19
    s_lshr_b32 s30, s2, 3
    s_mul_i32 s30, s30, 44032
    s_add_u32 s30, s30, 28672
    buffer_load_dword v156, v157, s[44:47], s30 offen
Lt19:
    s_cmp_lg_u32 s20, 2
    s_cbranch_scc1 Lt20
    s_lshr_b32 s30, s2, 3
    s_mul_i32 s30, s30, 44032
    s_add_u32 s30, s30, 32768
    buffer_load_dword v156, v157, s[44:47], s30 offen
Lt20:
    s_waitcnt lgkmcnt(10)
    v_mfma_f32_16x16x32_bf16 v[96:99], v[80:83], v[72:75], v[96:99]
    ds_read_b128 v[48:51], v41 offset:6144
    ds_read_b64_tr_b16 v[56:57], v9 offset:0
    v_mfma_f32_16x16x32_bf16 v[100:103], v[84:87], v[72:75], v[100:103]
    ds_read_b64_tr_b16 v[58:59], v9 offset:256
    ds_read_b64_tr_b16 v[60:61], v9 offset:2048
    v_mfma_f32_16x16x32_bf16 v[104:107], v[88:91], v[72:75], v[104:107]
    ds_read_b64_tr_b16 v[62:63], v9 offset:2304
    ds_read_b128 v[52:55], v44 offset:6144
    v_mfma_f32_16x16x32_bf16 v[108:111], v[80:83], v[76:79], v[108:111]
    ds_read_b64_tr_b16 v[64:65], v9 offset:4096
    ds_read_b64_tr_b16 v[66:67], v9 offset:4352
    v_mfma_f32_16x16x32_bf16 v[112:115], v[84:87], v[76:79], v[112:115]
    ds_read_b64_tr_b16 v[68:69], v12 offset:0
    ds_read_b64_tr_b16 v[70:71], v12 offset:256
    v_mfma_f32_16x16x32_bf16 v[116:119], v[88:91], v[76:79], v[116:119]
    v_mfma_f32_16x16x32_bf16 v[128:131], v[92:95], v[16:19], v[128:131]
    v_mfma_f32_16x16x32_bf16 v[120:123], v[16:19], v[72:75], v[120:123]
    v_mfma_f32_16x16x32_bf16 v[124:127], v[72:75], v[72:75], v[124:127]
    s_cmp_lg_u32 s20, 5
    s_cbranch_scc1 Lt21
    s_lshr_b32 s30, s2, 3
    s_mul_i32 s30, s30, 44032
    s_add_u32 s30, s30, 36864
    buffer_load_dword v156, v157, s[44:47], s30 offen
Lt21:
    s_cmp_lg_u32 s20, 0
    s_cbranch_scc1 Lt22
    s_lshr_b32 s30, s2, 3
    s_mul_i32 s30, s30, 44032
    s_add_u32 s30, s30, 39936
    buffer_load_dword v156, v157, s[44:47], s30 offen
Lt22:
    s_waitcnt lgkmcnt(10)
    v_mfma_f32_16x16x32_bf16 v[96:99], v[140:143], v[132:135], v[96:99]
    v_mfma_f32_16x16x32_bf16 v[100:103], v[144:147], v[132:135], v[100:103]
    v_mfma_f32_16x16x32_bf16 v[104:107], v[148:151], v[132:135], v[104:107]
    v_mfma_f32_16x16x32_bf16 v[108:111], v[140:143], v[136:139], v[108:111]
    v_mfma_f32_16x16x32_bf16 v[112:115], v[144:147], v[136:139], v[112:115]
    v_mfma_f32_16x16x32_bf16 v[116:119], v[148:151], v[136:139], v[116:119]
    v_mfma_f32_16x16x32_bf16 v[128:131], v[152:155], v[16:19], v[128:131]
    v_mfma_f32_16x16x32_bf16 v[120:123], v[16:19], v[132:135], v[120:123]
    v_mfma_f32_16x16x32_bf16 v[124:127], v[132:135], v[132:135], v[124:127]
    s_waitcnt lgkmcnt(0)
    v_mfma_f32_16x16x32_bf16 v[96:99], v[56:59], v[48:51], v[96:99]
    v_mfma_f32_16x16x32_bf16 v[100:103], v[60:63], v[48:51], v[100:103]
    v_mfma_f32_16x16x32_bf16 v[104:107], v[64:67], v[48:51], v[104:107]
    v_mfma_f32_16x16x32_bf16 v[108:111], v[56:59], v[52:55], v[108:111]
    v_mfma_f32_16x16x32_bf16 v[112:115], v[60:63], v[52:55], v[112:115]
    v_mfma_f32_16x16x32_bf16 v[116:119], v[64:67], v[52:55], v[116:119]
    v_mfma_f32_16x16x32_bf16 v[128:131], v[68:71], v[16:19], v[128:131]
    v_mfma_f32_16x16x32_bf16 v[120:123], v[16:19], v[48:51], v[120:123]
    v_mfma_f32_16x16x32_bf16 v[124:127], v[48:51], v[48:51], v[124:127]
    v_lshlrev_b32 v15, 4, v2
    s_lshl_b32 s27, s26, 6
    s_add_u32 s27, s27, 0x26800
    v_add_u32 v14, s27, v15
    s_nop 1
    ds_write_b128 v14, v[128:131]
    v_cmp_eq_u32 vcc, 1, v5
    s_nop 1
    v_cndmask_b32 v73, v124, v125, vcc
    v_cmp_eq_u32 vcc, 2, v5
    s_nop 1
    v_cndmask_b32 v73, v73, v126, vcc
    v_cmp_eq_u32 vcc, 3, v5
    s_nop 1
    v_cndmask_b32 v73, v73, v127, vcc
    v_cmp_eq_u32 vcc, v2, v4
    s_nop 1
    v_cndmask_b32 v73, 0, v73, vcc
    v_mov_b32 v72, v120
    v_mov_b32 v76, v73
    s_nop 1
    v_permlane16_swap_b32 v73, v76
    v_add_f32 v73, v73, v76
    v_mov_b32 v76, v73
    s_nop 1
    v_permlane32_swap_b32 v73, v76
    v_add_f32 v73, v73, v76
    v_mul_f32 v72, 0x3b000000, v72
    v_mul_f32 v73, 0x3b000000, v73
    v_fma_f32 v73, -v72, v72, v73
    v_max_f32 v73, 0, v73
    v_cvt_pk_bf16_f32 v36, v72, v72
    v_lshlrev_b32 v36, 16, v36
    v_cvt_pk_bf16_f32 v73, v73, v73
    v_lshlrev_b32 v73, 16, v73
    v_add_f32 v73, 0x3727c5ac, v73
    v_cvt_pk_bf16_f32 v73, v73, v73
    v_lshlrev_b32 v73, 16, v73
    v_sqrt_f32 v73, v73
    s_nop 0
    v_cvt_pk_bf16_f32 v73, v73, v73
    v_lshlrev_b32 v73, 16, v73
    v_rcp_f32 v37, v73
    s_lshl_b32 s27, s20, 7
    s_add_u32 s27, s27, 0x26a00
    v_lshlrev_b32 v74, 3, v3
    v_add_u32 v75, s27, v74
    ds_write_b64 v75, v[36:37]
    v_xor_b32 v75, 0x80, v75
    s_lshl_b32 s27, s36, 6
    s_add_u32 s27, s27, 0x26800
    v_add_u32 v15, s27, v15
    s_waitcnt lgkmcnt(0)
    s_barrier
    ds_read_b64 v[38:39], v75
    ds_read_b128 v[132:135], v15 offset:0
    ds_read_b128 v[136:139], v15 offset:128
    ds_read_b128 v[140:143], v15 offset:256
    s_waitcnt lgkmcnt(2)
    v_fma_f32 v96, -v36, v132, v96
    v_fma_f32 v97, -v36, v133, v97
    v_fma_f32 v98, -v36, v134, v98
    v_fma_f32 v99, -v36, v135, v99
    v_mul_f32 v96, v37, v96
    v_mul_f32 v97, v37, v97
    v_mul_f32 v98, v37, v98
    v_mul_f32 v99, v37, v99
    s_waitcnt lgkmcnt(1)
    v_fma_f32 v100, -v36, v136, v100
    v_fma_f32 v101, -v36, v137, v101
    v_fma_f32 v102, -v36, v138, v102
    v_fma_f32 v103, -v36, v139, v103
    v_mul_f32 v100, v37, v100
    v_mul_f32 v101, v37, v101
    v_mul_f32 v102, v37, v102
    v_mul_f32 v103, v37, v103
    s_waitcnt lgkmcnt(0)
    v_fma_f32 v104, -v36, v140, v104
    v_fma_f32 v105, -v36, v141, v105
    v_fma_f32 v106, -v36, v142, v106
    v_fma_f32 v107, -v36, v143, v107
    v_mul_f32 v104, v37, v104
    v_mul_f32 v105, v37, v105
    v_mul_f32 v106, v37, v106
    v_mul_f32 v107, v37, v107
    v_fma_f32 v108, -v38, v132, v108
    v_fma_f32 v109, -v38, v133, v109
    v_fma_f32 v110, -v38, v134, v110
    v_fma_f32 v111, -v38, v135, v111
    v_mul_f32 v108, v39, v108
    v_mul_f32 v109, v39, v109
    v_mul_f32 v110, v39, v110
    v_mul_f32 v111, v39, v111
    v_fma_f32 v112, -v38, v136, v112
    v_fma_f32 v113, -v38, v137, v113
    v_fma_f32 v114, -v38, v138, v114
    v_fma_f32 v115, -v38, v139, v115
    v_mul_f32 v112, v39, v112
    v_mul_f32 v113, v39, v113
    v_mul_f32 v114, v39, v114
    v_mul_f32 v115, v39, v115
    v_fma_f32 v116, -v38, v140, v116
    v_fma_f32 v117, -v38, v141, v117
    v_fma_f32 v118, -v38, v142, v118
    v_fma_f32 v119, -v38, v143, v119
    v_mul_f32 v116, v39, v116
    v_mul_f32 v117, v39, v117
    v_mul_f32 v118, v39, v118
    v_mul_f32 v119, v39, v119
    ds_read_b64_tr_b16 v[26:27], v22
    v_cvt_pk_bf16_f32 v144, v96, v97
    v_cvt_pk_bf16_f32 v145, v98, v99
    v_cvt_pk_bf16_f32 v146, v100, v101
    v_cvt_pk_bf16_f32 v147, v102, v103
    v_cvt_pk_bf16_f32 v148, v104, v105
    v_cvt_pk_bf16_f32 v149, v106, v107
    v_cvt_pk_bf16_f32 v150, v108, v109
    v_cvt_pk_bf16_f32 v151, v110, v111
    v_cvt_pk_bf16_f32 v152, v112, v113
    v_cvt_pk_bf16_f32 v153, v114, v115
    v_cvt_pk_bf16_f32 v154, v116, v117
    v_cvt_pk_bf16_f32 v155, v118, v119
    s_waitcnt lgkmcnt(0)
    v_mfma_f32_16x16x16_bf16 v[48:51], v[26:27], v[146:147], 0
    v_mfma_f32_16x16x16_bf16 v[52:55], v[26:27], v[152:153], 0
    v_mfma_f32_16x16x16_bf16 v[56:59], v[26:27], v[144:145], 0
    v_mfma_f32_16x16x16_bf16 v[60:63], v[26:27], v[150:151], 0
    v_mfma_f32_16x16x16_bf16 v[64:67], v[148:149], v[20:21], 0
    v_mfma_f32_16x16x16_bf16 v[68:71], v[154:155], v[20:21], 0
    s_nop 4
    v_cvt_pk_bf16_f32 v98, v56, v57
    v_cvt_pk_bf16_f32 v99, v58, v59
    v_cvt_pk_bf16_f32 v110, v60, v61
    v_cvt_pk_bf16_f32 v111, v62, v63
    v_cvt_pk_bf16_f32 v74, v48, v49
    v_cvt_pk_bf16_f32 v75, v50, v51
    v_cvt_pk_bf16_f32 v86, v52, v53
    v_cvt_pk_bf16_f32 v87, v54, v55
    v_lshlrev_b32 v48, 16, v74
    v_and_b32 v49, 0xffff0000, v74
    v_lshlrev_b32 v50, 16, v75
    v_and_b32 v51, 0xffff0000, v75
    v_lshlrev_b32 v52, 16, v86
    v_and_b32 v53, 0xffff0000, v86
    v_lshlrev_b32 v54, 16, v87
    v_and_b32 v55, 0xffff0000, v87
    v_max3_f32 v72, v48, v49, v50
    v_min3_f32 v73, v48, v49, v50
    v_max_f32 v72, v72, v51
    v_min_f32 v73, v73, v51
    v_max3_f32 v84, v52, v53, v54
    v_min3_f32 v85, v52, v53, v54
    v_max_f32 v84, v84, v55
    v_min_f32 v85, v85, v55
    v_mov_b32 v74, v72
    v_mov_b32 v75, v73
    v_mov_b32 v86, v84
    v_mov_b32 v87, v85
    v_permlane16_swap_b32 v72, v74
    v_permlane16_swap_b32 v73, v75
    v_permlane16_swap_b32 v84, v86
    v_permlane16_swap_b32 v85, v87
    v_max_f32 v72, v72, v74
    v_min_f32 v73, v73, v75
    v_max_f32 v84, v84, v86
    v_min_f32 v85, v85, v87
    v_mov_b32 v74, v72
    v_mov_b32 v75, v73
    v_mov_b32 v86, v84
    v_mov_b32 v87, v85
    v_permlane32_swap_b32 v72, v74
    v_permlane32_swap_b32 v73, v75
    v_permlane32_swap_b32 v84, v86
    v_permlane32_swap_b32 v85, v87
    v_max_f32 v72, v72, v74
    v_min_f32 v73, v73, v75
    v_max_f32 v84, v84, v86
    v_min_f32 v85, v85, v87
    v_mul_f32 v72, 0xbfb8aa3b, v72
    v_mul_f32 v73, 0x3fb8aa3b, v73
    v_mul_f32 v84, 0xbfb8aa3b, v84
    v_mul_f32 v85, 0x3fb8aa3b, v85
    v_mov_b32 v28, 0x3fb8aa3b
    v_fma_f32 v76, v48, v28, v72
    v_fma_f32 v80, -v48, v28, v73
    v_fma_f32 v77, v49, v28, v72
    v_fma_f32 v81, -v49, v28, v73
    v_fma_f32 v78, v50, v28, v72
    v_fma_f32 v82, -v50, v28, v73
    v_fma_f32 v79, v51, v28, v72
    v_fma_f32 v83, -v51, v28, v73
    v_fma_f32 v88, v52, v28, v84
    v_fma_f32 v92, -v52, v28, v85
    v_fma_f32 v89, v53, v28, v84
    v_fma_f32 v93, -v53, v28, v85
    v_fma_f32 v90, v54, v28, v84
    v_fma_f32 v94, -v54, v28, v85
    v_fma_f32 v91, v55, v28, v84
    v_fma_f32 v95, -v55, v28, v85
    v_exp_f32 v76, v76
    v_exp_f32 v77, v77
    v_exp_f32 v78, v78
    v_exp_f32 v79, v79
    v_exp_f32 v80, v80
    v_exp_f32 v81, v81
    v_exp_f32 v82, v82
    v_exp_f32 v83, v83
    v_exp_f32 v88, v88
    v_exp_f32 v89, v89
    v_exp_f32 v90, v90
    v_exp_f32 v91, v91
    v_exp_f32 v92, v92
    v_exp_f32 v93, v93
    v_exp_f32 v94, v94
    v_exp_f32 v95, v95
    v_add_f32 v72, v76, v77
    v_add_f32 v73, v80, v81
    v_add_f32 v74, v78, v79
    v_add_f32 v75, v82, v83
    v_add_f32 v84, v88, v89
    v_add_f32 v85, v92, v93
    v_add_f32 v86, v90, v91
    v_add_f32 v87, v94, v95
    v_add_f32 v72, v72, v74
    v_add_f32 v73, v73, v75
    v_add_f32 v84, v84, v86
    v_add_f32 v85, v85, v87
    v_mov_b32 v74, v72
    v_mov_b32 v75, v73
    v_mov_b32 v86, v84
    v_mov_b32 v87, v85
    v_permlane16_swap_b32 v72, v74
    v_permlane16_swap_b32 v73, v75
    v_permlane16_swap_b32 v84, v86
    v_permlane16_swap_b32 v85, v87
    v_add_f32 v72, v72, v74
    v_add_f32 v73, v73, v75
    v_add_f32 v84, v84, v86
    v_add_f32 v85, v85, v87
    v_mov_b32 v74, v72
    v_mov_b32 v75, v73
    v_mov_b32 v86, v84
    v_mov_b32 v87, v85
    v_permlane32_swap_b32 v72, v74
    v_permlane32_swap_b32 v73, v75
    v_permlane32_swap_b32 v84, v86
    v_permlane32_swap_b32 v85, v87
    v_add_f32 v72, v72, v74
    v_add_f32 v73, v73, v75
    v_add_f32 v84, v84, v86
    v_add_f32 v85, v85, v87
    v_rcp_f32 v72, v72
    v_rcp_f32 v73, v73
    v_rcp_f32 v84, v84
    v_rcp_f32 v85, v85
    v_mul_f32 v76, v72, v76
    v_mul_f32 v80, v73, v80
    v_mul_f32 v77, v72, v77
    v_mul_f32 v81, v73, v81
    v_mul_f32 v78, v72, v78
    v_mul_f32 v82, v73, v82
    v_mul_f32 v79, v72, v79
    v_mul_f32 v83, v73, v83
    v_mul_f32 v88, v84, v88
    v_mul_f32 v92, v85, v92
    v_mul_f32 v89, v84, v89
    v_mul_f32 v93, v85, v93
    v_mul_f32 v90, v84, v90
    v_mul_f32 v94, v85, v94
    v_mul_f32 v91, v84, v91
    v_mul_f32 v95, v85, v95
    v_cvt_pk_bf16_f32 v120, v76, v77
    v_cvt_pk_bf16_f32 v121, v78, v79
    v_cvt_pk_bf16_f32 v122, v80, v81
    v_cvt_pk_bf16_f32 v123, v82, v83
    v_cvt_pk_bf16_f32 v124, v88, v89
    v_cvt_pk_bf16_f32 v125, v90, v91
    v_cvt_pk_bf16_f32 v126, v92, v93
    v_cvt_pk_bf16_f32 v127, v94, v95
    s_xor_b32 s30, s99, 0x10000
    buffer_store_dwordx2 v[98:99], v165, s[16:19], s99 offen sc1
    buffer_store_dwordx2 v[110:111], v165, s[16:19], s30 offen sc1
    v_mfma_f32_16x16x16_bf16 v[72:75], v[120:121], v[20:21], 0
    v_mfma_f32_16x16x16_bf16 v[76:79], v[122:123], v[20:21], 0
    v_mfma_f32_16x16x16_bf16 v[80:83], v[124:125], v[20:21], 0
    v_mfma_f32_16x16x16_bf16 v[84:87], v[126:127], v[20:21], 0
    v_cvt_pk_bf16_f32 v88, v64, v65
    v_cvt_pk_bf16_f32 v89, v66, v67
    v_cvt_pk_bf16_f32 v90, v68, v69
    v_cvt_pk_bf16_f32 v91, v70, v71
    s_nop 0
    v_cvt_pk_bf16_f32 v92, v72, v73
    v_cvt_pk_bf16_f32 v93, v74, v75
    v_cvt_pk_bf16_f32 v94, v76, v77
    v_cvt_pk_bf16_f32 v95, v78, v79
    v_cvt_pk_bf16_f32 v96, v80, v81
    v_cvt_pk_bf16_f32 v97, v82, v83
    v_cvt_pk_bf16_f32 v98, v84, v85
    v_cvt_pk_bf16_f32 v99, v86, v87
    v_mfma_f32_16x16x16_bf16 v[128:131], v[92:93], v[88:89], 0
    v_mfma_f32_16x16x16_bf16 v[136:139], v[92:93], v[16:17], 0
    v_mfma_f32_16x16x16_bf16 v[132:135], v[94:95], v[88:89], 0
    v_mfma_f32_16x16x16_bf16 v[140:143], v[94:95], v[16:17], 0
    v_mfma_f32_16x16x16_bf16 v[128:131], v[96:97], v[90:91], v[128:131]
    v_mfma_f32_16x16x16_bf16 v[136:139], v[96:97], v[16:17], v[136:139]
    v_mfma_f32_16x16x16_bf16 v[132:135], v[98:99], v[90:91], v[132:135]
    v_mfma_f32_16x16x16_bf16 v[140:143], v[98:99], v[16:17], v[140:143]
    s_lshl_b32 s30, s20, 12
    v_add_u32 v23, s30, v6
    s_nop 2
    ds_write_b128 v23, v[128:131] offset:0
    s_nop 0
    ds_write_b128 v23, v[132:135] offset:1024
    ds_write_b128 v23, v[136:139] offset:2048
    ds_write_b128 v23, v[140:143] offset:3072
    s_lshl_b32 s30, s20, 10
    v_add_u32 v24, s30, v6
    s_lshr_b32 s21, s2, 3
    s_and_b32 s22, s2, 7
    s_lshl_b32 s22, s22, 3
    s_add_u32 s22, s22, s20
    s_lshl_b32 s22, s22, 17
    s_lshl_b32 s23, s21, 9
    s_add_u32 s22, s22, s23
    s_add_u32 s23, s22, 0x10000
    v_lshlrev_b32 v7, 3, v1
    s_lshr_b32 s24, s20, 1
    s_lshl_b32 s24, s24, 7
    s_add_u32 s24, s24, s21
    s_mul_i32 s24, s24, 1152
    s_add_u32 s24, s24, 0x800000
    s_and_b32 s25, s20, 1
    s_lshl_b32 s26, s25, 9
    s_lshl_b32 s27, s25, 6
    s_add_u32 s26, s26, s24
    s_add_u32 s27, s27, s24
    s_add_u32 s27, s27, 1024
    v_lshlrev_b32 v8, 4, v2
    s_waitcnt lgkmcnt(0)
    v_mov_b32 v22, 0x27800
    s_barrier
    ds_read_b32 v23, v22
    ds_read_b128 v[48:51], v24 offset:0
    ds_read_b128 v[52:55], v24 offset:8192
    ds_read_b128 v[56:59], v24 offset:16384
    ds_read_b128 v[60:63], v24 offset:24576
    s_waitcnt lgkmcnt(2)
    v_add_f32 v48, v48, v52
    v_add_f32 v49, v49, v53
    v_add_f32 v50, v50, v54
    v_add_f32 v51, v51, v55
    s_waitcnt lgkmcnt(1)
    v_add_f32 v48, v48, v56
    v_add_f32 v49, v49, v57
    v_add_f32 v50, v50, v58
    v_add_f32 v51, v51, v59
    s_waitcnt lgkmcnt(0)
    v_add_f32 v48, v48, v60
    v_add_f32 v49, v49, v61
    v_add_f32 v50, v50, v62
    v_add_f32 v51, v51, v63
    s_bitcmp1_b32 s20, 1
    s_cbranch_scc1 Lz23
    v_cvt_pk_bf16_f32 v48, v48, v49
    v_cvt_pk_bf16_f32 v49, v50, v51
    buffer_store_dwordx2 v[48:49], v165, s[16:19], s98 offen sc1
    s_branch Le24
Lz23:
    s_mov_b64 exec, s[96:97]
    buffer_store_dwordx4 v[48:51], v164, s[16:19], s98 offen sc1
    s_mov_b64 exec, -1
Le24:
    s_mov_b32 s28, 262144
c_rw:
    v_readfirstlane_b32 s3, v23
    s_sub_u32 s28, s28, 1
    s_cbranch_scc1 c_rok
    ds_read_b32 v23, v22
    s_sleep 1
    s_cmp_eq_u32 s3, 0
    s_waitcnt lgkmcnt(0)
    s_cbranch_scc1 c_rw
c_rok:
    s_lshr_b32 s3, s3, 1
    s_mov_b32 s28, 4096
ko_pq:
    buffer_load_dwordx2 v[26:27], v7, s[16:19], s22 offen sc1
    buffer_load_dwordx2 v[38:39], v7, s[16:19], s23 offen sc1
    s_waitcnt vmcnt(0)
ko_pqc:
    s_sub_u32 s28, s28, 1
    s_cbranch_scc1 ko_pq_ok
    v_max3_u32 v9, v26, v27, v38
    v_max_u32 v9, v9, v39
    v_cmp_eq_u32 vcc, -1, v9
    s_cbranch_vccnz ko_pq
ko_pq_ok:
    s_lshl_b32 s30, s20, 11
    s_add_u32 s30, s30, 0x8000
    v_add_u32 v9, s30, v6
    v_lshlrev_b32 v16, 16, v26
    v_and_b32 v17, 0xffff0000, v26
    v_lshlrev_b32 v18, 16, v27
    v_and_b32 v19, 0xffff0000, v27
    v_lshlrev_b32 v20, 16, v38
    v_and_b32 v21, 0xffff0000, v38
    v_lshlrev_b32 v22, 16, v39
    v_and_b32 v23, 0xffff0000, v39
    v_max3_f32 v24, v16, v17, v18
    v_min3_f32 v25, v16, v17, v18
    v_max_f32 v24, v24, v19
    v_min_f32 v25, v25, v19
    v_max3_f32 v36, v20, v21, v22
    v_min3_f32 v37, v20, v21, v22
    v_max_f32 v36, v36, v23
    v_min_f32 v37, v37, v23
    v_mov_b32 v26, v24
    v_mov_b32 v27, v25
    v_mov_b32 v38, v36
    v_mov_b32 v39, v37
    v_permlane16_swap_b32 v24, v26
    v_permlane16_swap_b32 v25, v27
    v_permlane16_swap_b32 v36, v38
    v_permlane16_swap_b32 v37, v39
    v_max_f32 v24, v24, v26
    v_min_f32 v25, v25, v27
    v_max_f32 v36, v36, v38
    v_min_f32 v37, v37, v39
    v_mov_b32 v26, v24
    v_mov_b32 v27, v25
    v_mov_b32 v38, v36
    v_mov_b32 v39, v37
    v_permlane32_swap_b32 v24, v26
    v_permlane32_swap_b32 v25, v27
    v_permlane32_swap_b32 v36, v38
    v_permlane32_swap_b32 v37, v39
    v_max_f32 v24, v24, v26
    v_min_f32 v25, v25, v27
    v_max_f32 v36, v36, v38
    v_min_f32 v37, v37, v39
    v_mul_f32 v24, 0xbfb8aa3b, v24
    v_mul_f32 v25, 0x3fb8aa3b, v25
    v_mul_f32 v36, 0xbfb8aa3b, v36
    v_mul_f32 v37, 0x3fb8aa3b, v37
    v_mov_b32 v10, 0x3fb8aa3b
    v_fma_f32 v28, v16, v10, v24
    v_fma_f32 v32, -v16, v10, v25
    v_fma_f32 v29, v17, v10, v24
    v_fma_f32 v33, -v17, v10, v25
    v_fma_f32 v30, v18, v10, v24
    v_fma_f32 v34, -v18, v10, v25
    v_fma_f32 v31, v19, v10, v24
    v_fma_f32 v35, -v19, v10, v25
    v_fma_f32 v40, v20, v10, v36
    v_fma_f32 v44, -v20, v10, v37
    v_fma_f32 v41, v21, v10, v36
    v_fma_f32 v45, -v21, v10, v37
    v_fma_f32 v42, v22, v10, v36
    v_fma_f32 v46, -v22, v10, v37
    v_fma_f32 v43, v23, v10, v36
    v_fma_f32 v47, -v23, v10, v37
    v_exp_f32 v28, v28
    v_exp_f32 v29, v29
    v_exp_f32 v30, v30
    v_exp_f32 v31, v31
    v_exp_f32 v32, v32
    v_exp_f32 v33, v33
    v_exp_f32 v34, v34
    v_exp_f32 v35, v35
    v_exp_f32 v40, v40
    v_exp_f32 v41, v41
    v_exp_f32 v42, v42
    v_exp_f32 v43, v43
    v_exp_f32 v44, v44
    v_exp_f32 v45, v45
    v_exp_f32 v46, v46
    v_exp_f32 v47, v47
    v_add_f32 v24, v28, v29
    v_add_f32 v25, v32, v33
    v_add_f32 v26, v30, v31
    v_add_f32 v27, v34, v35
    v_add_f32 v36, v40, v41
    v_add_f32 v37, v44, v45
    v_add_f32 v38, v42, v43
    v_add_f32 v39, v46, v47
    v_add_f32 v24, v24, v26
    v_add_f32 v25, v25, v27
    v_add_f32 v36, v36, v38
    v_add_f32 v37, v37, v39
    v_mov_b32 v26, v24
    v_mov_b32 v27, v25
    v_mov_b32 v38, v36
    v_mov_b32 v39, v37
    v_permlane16_swap_b32 v24, v26
    v_permlane16_swap_b32 v25, v27
    v_permlane16_swap_b32 v36, v38
    v_permlane16_swap_b32 v37, v39
    v_add_f32 v24, v24, v26
    v_add_f32 v25, v25, v27
    v_add_f32 v36, v36, v38
    v_add_f32 v37, v37, v39
    v_mov_b32 v26, v24
    v_mov_b32 v27, v25
    v_mov_b32 v38, v36
    v_mov_b32 v39, v37
    v_permlane32_swap_b32 v24, v26
    v_permlane32_swap_b32 v25, v27
    v_permlane32_swap_b32 v36, v38
    v_permlane32_swap_b32 v37, v39
    v_add_f32 v24, v24, v26
    v_add_f32 v25, v25, v27
    v_add_f32 v36, v36, v38
    v_add_f32 v37, v37, v39
    v_rcp_f32 v24, v24
    v_rcp_f32 v25, v25
    v_rcp_f32 v36, v36
    v_rcp_f32 v37, v37
    v_mul_f32 v28, v24, v28
    v_mul_f32 v32, v25, v32
    v_mul_f32 v29, v24, v29
    v_mul_f32 v33, v25, v33
    v_mul_f32 v30, v24, v30
    v_mul_f32 v34, v25, v34
    v_mul_f32 v31, v24, v31
    v_mul_f32 v35, v25, v35
    v_mul_f32 v40, v36, v40
    v_mul_f32 v44, v37, v44
    v_mul_f32 v41, v36, v41
    v_mul_f32 v45, v37, v45
    v_mul_f32 v42, v36, v42
    v_mul_f32 v46, v37, v46
    v_mul_f32 v43, v36, v43
    v_mul_f32 v47, v37, v47
    v_cvt_pk_bf16_f32 v52, v28, v29
    v_cvt_pk_bf16_f32 v53, v30, v31
    v_cvt_pk_bf16_f32 v54, v32, v33
    v_cvt_pk_bf16_f32 v55, v34, v35
    v_cvt_pk_bf16_f32 v56, v40, v41
    v_cvt_pk_bf16_f32 v57, v42, v43
    v_cvt_pk_bf16_f32 v58, v44, v45
    v_cvt_pk_bf16_f32 v59, v46, v47
    s_mov_b32 s28, 4096
ko_pp:
    s_add_u32 s30, s26, 0
    s_add_u32 s31, s27, 0
    buffer_load_dwordx2 v[64:65], v7, s[16:19], s30 offen sc1
    buffer_load_dwordx4 v[80:83], v8, s[16:19], s31 offen sc1
    s_add_u32 s30, s26, 36864
    s_add_u32 s31, s27, 36864
    buffer_load_dwordx2 v[68:69], v7, s[16:19], s30 offen sc1
    buffer_load_dwordx4 v[84:87], v8, s[16:19], s31 offen sc1
    s_add_u32 s30, s26, 73728
    s_add_u32 s31, s27, 73728
    buffer_load_dwordx2 v[72:73], v7, s[16:19], s30 offen sc1
    buffer_load_dwordx4 v[88:91], v8, s[16:19], s31 offen sc1
    s_add_u32 s30, s26, 110592
    s_add_u32 s31, s27, 110592
    buffer_load_dwordx2 v[76:77], v7, s[16:19], s30 offen sc1
    buffer_load_dwordx4 v[92:95], v8, s[16:19], s31 offen sc1
ko_ppc:
    s_sub_u32 s28, s28, 1
    s_cbranch_scc1 ko_pp_ok
    s_waitcnt vmcnt(0)
    v_max3_u32 v11, v64, v65, v68
    v_max3_u32 v12, v69, v72, v73
    v_max3_u32 v11, v11, v76, v77
    v_max3_u32 v12, v12, v80, v81
    v_max3_u32 v11, v11, v82, v83
    v_max3_u32 v12, v12, v84, v85
    v_max3_u32 v11, v11, v86, v87
    v_max3_u32 v12, v12, v88, v89
    v_max3_u32 v11, v11, v90, v91
    v_max3_u32 v12, v12, v92, v93
    v_max3_u32 v11, v11, v94, v95
    v_max_u32 v11, v11, v12
    v_cmp_eq_u32 vcc, -1, v11
    s_cbranch_vccnz ko_pp
ko_pp_ok:
    s_waitcnt vmcnt(0)
    v_and_b32 v67, 0xffff0000, v65
    v_lshlrev_b32 v66, 16, v65
    v_and_b32 v65, 0xffff0000, v64
    v_lshlrev_b32 v64, 16, v64
    v_and_b32 v71, 0xffff0000, v69
    v_lshlrev_b32 v70, 16, v69
    v_and_b32 v69, 0xffff0000, v68
    v_lshlrev_b32 v68, 16, v68
    v_and_b32 v75, 0xffff0000, v73
    v_lshlrev_b32 v74, 16, v73
    v_and_b32 v73, 0xffff0000, v72
    v_lshlrev_b32 v72, 16, v72
    v_and_b32 v79, 0xffff0000, v77
    v_lshlrev_b32 v78, 16, v77
    v_and_b32 v77, 0xffff0000, v76
    v_lshlrev_b32 v76, 16, v76
    v_add_f32 v64, v64, v68
    v_add_f32 v72, v72, v76
    v_add_f32 v65, v65, v69
    v_add_f32 v73, v73, v77
    v_add_f32 v66, v66, v70
    v_add_f32 v74, v74, v78
    v_add_f32 v67, v67, v71
    v_add_f32 v75, v75, v79
    v_add_f32 v64, v64, v72
    v_add_f32 v65, v65, v73
    v_add_f32 v66, v66, v74
    v_add_f32 v67, v67, v75
    v_add_f32 v80, v80, v84
    v_add_f32 v88, v88, v92
    v_add_f32 v81, v81, v85
    v_add_f32 v89, v89, v93
    v_add_f32 v82, v82, v86
    v_add_f32 v90, v90, v94
    v_add_f32 v83, v83, v87
    v_add_f32 v91, v91, v95
    v_add_f32 v80, v80, v88
    v_add_f32 v81, v81, v89
    v_add_f32 v82, v82, v90
    v_add_f32 v83, v83, v91
    ds_write_b128 v9, v[64:67]
    ds_write_b128 v9, v[80:83] offset:1024
    s_waitcnt lgkmcnt(0)
    s_barrier
    ds_read_b128 v[64:67], v6 offset:32768
    ds_read_b128 v[68:71], v6 offset:36864
    ds_read_b128 v[72:75], v6 offset:40960
    ds_read_b128 v[76:79], v6 offset:45056
    ds_read_b128 v[80:83], v6 offset:33792
    ds_read_b128 v[84:87], v6 offset:37888
    ds_read_b128 v[88:91], v6 offset:41984
    ds_read_b128 v[92:95], v6 offset:46080
    ds_read_b128 v[96:99], v6 offset:34816
    ds_read_b128 v[100:103], v6 offset:38912
    ds_read_b128 v[104:107], v6 offset:43008
    ds_read_b128 v[108:111], v6 offset:47104
    ds_read_b128 v[112:115], v6 offset:35840
    ds_read_b128 v[116:119], v6 offset:39936
    ds_read_b128 v[120:123], v6 offset:44032
    ds_read_b128 v[124:127], v6 offset:48128
    s_waitcnt lgkmcnt(12)
    v_add_f32 v64, v64, v68
    v_add_f32 v72, v72, v76
    v_add_f32 v65, v65, v69
    v_add_f32 v73, v73, v77
    v_add_f32 v66, v66, v70
    v_add_f32 v74, v74, v78
    v_add_f32 v67, v67, v71
    v_add_f32 v75, v75, v79
    v_add_f32 v64, v64, v72
    v_add_f32 v65, v65, v73
    v_add_f32 v66, v66, v74
    v_add_f32 v67, v67, v75
    v_cvt_pk_bf16_f32 v128, v64, v65
    v_cvt_pk_bf16_f32 v129, v66, v67
    s_waitcnt lgkmcnt(8)
    v_add_f32 v80, v80, v84
    v_add_f32 v88, v88, v92
    v_add_f32 v81, v81, v85
    v_add_f32 v89, v89, v93
    v_add_f32 v82, v82, v86
    v_add_f32 v90, v90, v94
    v_add_f32 v83, v83, v87
    v_add_f32 v91, v91, v95
    v_add_f32 v80, v80, v88
    v_add_f32 v81, v81, v89
    v_add_f32 v82, v82, v90
    v_add_f32 v83, v83, v91
    v_cvt_pk_bf16_f32 v132, v80, v81
    v_cvt_pk_bf16_f32 v133, v82, v83
    s_waitcnt lgkmcnt(4)
    v_add_f32 v96, v96, v100
    v_add_f32 v104, v104, v108
    v_add_f32 v97, v97, v101
    v_add_f32 v105, v105, v109
    v_add_f32 v98, v98, v102
    v_add_f32 v106, v106, v110
    v_add_f32 v99, v99, v103
    v_add_f32 v107, v107, v111
    v_add_f32 v96, v96, v104
    v_add_f32 v97, v97, v105
    v_add_f32 v98, v98, v106
    v_add_f32 v99, v99, v107
    v_cvt_pk_bf16_f32 v130, v96, v97
    v_cvt_pk_bf16_f32 v131, v98, v99
    s_waitcnt lgkmcnt(0)
    v_add_f32 v112, v112, v116
    v_add_f32 v120, v120, v124
    v_add_f32 v113, v113, v117
    v_add_f32 v121, v121, v125
    v_add_f32 v114, v114, v118
    v_add_f32 v122, v122, v126
    v_add_f32 v115, v115, v119
    v_add_f32 v123, v123, v127
    v_add_f32 v112, v112, v120
    v_add_f32 v113, v113, v121
    v_add_f32 v114, v114, v122
    v_add_f32 v115, v115, v123
    v_cvt_pk_bf16_f32 v134, v112, v113
    v_cvt_pk_bf16_f32 v135, v114, v115
    v_mfma_f32_16x16x32_bf16 v[64:67], v[128:131], v[52:55], 0
    s_nop 0
    v_mfma_f32_16x16x32_bf16 v[68:71], v[132:135], v[52:55], 0
    v_mfma_f32_16x16x32_bf16 v[72:75], v[128:131], v[56:59], 0
    v_mfma_f32_16x16x32_bf16 v[76:79], v[132:135], v[56:59], 0
    s_nop 5
    v_cvt_pk_bf16_f32 v16, v68, v68
    v_cvt_pk_bf16_f32 v17, v64, v65
    v_cvt_pk_bf16_f32 v18, v66, v67
    v_lshlrev_b32 v16, 16, v16
    v_add_f32 v16, 0x358637bd, v16
    v_cvt_pk_bf16_f32 v16, v16, v16
    v_lshlrev_b32 v16, 16, v16
    v_rcp_f32 v16, v16
    v_lshlrev_b32 v19, 16, v17
    v_and_b32 v20, 0xffff0000, v17
    v_lshlrev_b32 v21, 16, v18
    v_and_b32 v22, 0xffff0000, v18
    v_mul_f32 v19, v16, v19
    v_mul_f32 v20, v16, v20
    v_mul_f32 v21, v16, v21
    v_mul_f32 v22, v16, v22
    v_cvt_pk_bf16_f32 v16, v19, v20
    v_cvt_pk_bf16_f32 v17, v21, v22
    s_cmp_eq_u32 s3, 0
    s_cbranch_scc1 Ls25
    buffer_store_dwordx2 v[16:17], v7, s[16:19], s22 offen
    s_branch Le26
Ls25:
    buffer_store_dwordx2 v[16:17], v7, s[16:19], s22 offen sc1
Le26:
    v_cvt_pk_bf16_f32 v24, v76, v76
    v_cvt_pk_bf16_f32 v25, v72, v73
    v_cvt_pk_bf16_f32 v26, v74, v75
    v_lshlrev_b32 v24, 16, v24
    v_add_f32 v24, 0x358637bd, v24
    v_cvt_pk_bf16_f32 v24, v24, v24
    v_lshlrev_b32 v24, 16, v24
    v_rcp_f32 v24, v24
    v_lshlrev_b32 v27, 16, v25
    v_and_b32 v28, 0xffff0000, v25
    v_lshlrev_b32 v29, 16, v26
    v_and_b32 v30, 0xffff0000, v26
    v_mul_f32 v27, v24, v27
    v_mul_f32 v28, v24, v28
    v_mul_f32 v29, v24, v29
    v_mul_f32 v30, v24, v30
    v_cvt_pk_bf16_f32 v24, v27, v28
    v_cvt_pk_bf16_f32 v25, v29, v30
    s_cmp_eq_u32 s3, 0
    s_cbranch_scc1 Ls27
    buffer_store_dwordx2 v[24:25], v7, s[16:19], s23 offen
    s_branch Le28
Ls27:
    buffer_store_dwordx2 v[24:25], v7, s[16:19], s23 offen sc1
Le28:
    s_and_b32 s30, s2, 7
    s_lshr_b32 s31, s2, 3
    s_lshl_b32 s21, s30, 2
    s_and_b32 s22, s31, 3
    s_add_u32 s21, s21, s22
    s_lshr_b32 s22, s31, 2
    s_and_b32 s31, s22, 3
    s_cmp_eq_u32 s31, 3
    s_cselect_b32 s31, 4, 0
    s_xor_b32 s22, s22, s31
    s_lshl_b32 s21, s21, 2
    s_lshl_b32 s22, s22, 7
    s_lshr_b32 s23, s20, 1
    s_add_u32 s24, s21, s23
    s_and_b32 s25, s20, 1
    v_lshl_add_u32 v14, v2, 2, v4
    v_lshlrev_b32 v14, 7, v14
    v_lshl_add_u32 v14, v5, 3, v14
    v_and_b32 v15, 1, v2
    v_lshlrev_b32 v15, 1, v15
    v_lshrrev_b32 v13, 1, v4
    v_or_b32 v15, v15, v13
    s_lshl_b32 s26, s25, 1
    v_xor_b32 v15, s26, v15
    v_lshl_add_u32 v14, v15, 5, v14
    s_lshl_b32 s26, s25, 12
    s_add_u32 s26, s26, 0x12000
    v_add_u32 v8, s26, v14
    v_xor_b32 v9, 32, v8
    v_xor_b32 v10, 64, v8
    v_xor_b32 v11, 96, v8
    s_lshl_b32 s26, s23, 11
    s_lshl_b32 s27, s25, 6
    s_add_u32 s26, s26, s27
    s_add_u32 s26, s26, 0x22000
    v_lshlrev_b32 v13, 7, v3
    v_lshl_add_u32 v13, v2, 3, v13
    v_add_u32 v13, s26, v13
    v_mov_b32 v14, 1
    v_mov_b32 v15, 0
    s_waitcnt vmcnt(0)
    s_mov_b64 exec, 1
    s_cmp_eq_u32 s3, 0
    s_cbranch_scc1 Ls29
    buffer_store_byte v14, v15, s[16:19], s0 offen
    s_branch Le30
Ls29:
    buffer_store_byte v14, v15, s[16:19], s0 offen sc1
Le30:
    s_mov_b64 exec, -1
    s_barrier
    ds_read_b64 v[164:165], v13 offset:0
    ds_read_b64 v[166:167], v13 offset:32
    ds_read_b64_tr_b16 v[64:65], v8 offset:0
    ds_read_b64_tr_b16 v[66:67], v8 offset:2048
    ds_read_b64_tr_b16 v[68:69], v9 offset:0
    ds_read_b64_tr_b16 v[70:71], v9 offset:2048
    ds_read_b64_tr_b16 v[72:73], v10 offset:0
    ds_read_b64_tr_b16 v[74:75], v10 offset:2048
    ds_read_b64_tr_b16 v[76:77], v11 offset:0
    ds_read_b64_tr_b16 v[78:79], v11 offset:2048
    ds_read_b64_tr_b16 v[80:81], v8 offset:8192
    ds_read_b64_tr_b16 v[82:83], v8 offset:10240
    ds_read_b64_tr_b16 v[84:85], v9 offset:8192
    ds_read_b64_tr_b16 v[86:87], v9 offset:10240
    ds_read_b64_tr_b16 v[88:89], v10 offset:8192
    ds_read_b64_tr_b16 v[90:91], v10 offset:10240
    ds_read_b64_tr_b16 v[92:93], v11 offset:8192
    ds_read_b64_tr_b16 v[94:95], v11 offset:10240
    ds_read_b64_tr_b16 v[96:97], v8 offset:16384
    ds_read_b64_tr_b16 v[98:99], v8 offset:18432
    ds_read_b64_tr_b16 v[100:101], v9 offset:16384
    ds_read_b64_tr_b16 v[102:103], v9 offset:18432
    ds_read_b64_tr_b16 v[104:105], v10 offset:16384
    ds_read_b64_tr_b16 v[106:107], v10 offset:18432
    ds_read_b64_tr_b16 v[108:109], v11 offset:16384
    ds_read_b64_tr_b16 v[110:111], v11 offset:18432
    ds_read_b64_tr_b16 v[112:113], v8 offset:24576
    ds_read_b64_tr_b16 v[114:115], v8 offset:26624
    ds_read_b64_tr_b16 v[116:117], v9 offset:24576
    ds_read_b64_tr_b16 v[118:119], v9 offset:26624
    ds_read_b64_tr_b16 v[120:121], v10 offset:24576
    ds_read_b64_tr_b16 v[122:123], v10 offset:26624
    ds_read_b64_tr_b16 v[124:125], v11 offset:24576
    ds_read_b64_tr_b16 v[126:127], v11 offset:26624
    ds_read_b64_tr_b16 v[128:129], v8 offset:32768
    ds_read_b64_tr_b16 v[130:131], v8 offset:34816
    ds_read_b64_tr_b16 v[132:133], v9 offset:32768
    ds_read_b64_tr_b16 v[134:135], v9 offset:34816
    ds_read_b64_tr_b16 v[136:137], v10 offset:32768
    ds_read_b64_tr_b16 v[138:139], v10 offset:34816
    ds_read_b64_tr_b16 v[140:141], v11 offset:32768
    ds_read_b64_tr_b16 v[142:143], v11 offset:34816
    ds_read_b64_tr_b16 v[144:145], v8 offset:40960
    ds_read_b64_tr_b16 v[146:147], v8 offset:43008
    ds_read_b64_tr_b16 v[148:149], v9 offset:40960
    ds_read_b64_tr_b16 v[150:151], v9 offset:43008
    ds_read_b64_tr_b16 v[152:153], v10 offset:40960
    ds_read_b64_tr_b16 v[154:155], v10 offset:43008
    ds_read_b64_tr_b16 v[156:157], v11 offset:40960
    ds_read_b64_tr_b16 v[158:159], v11 offset:43008
    s_and_b32 s30, s2, 7
    s_lshl_b32 s30, s30, 8
    s_and_b32 s31, s24, 15
    s_lshr_b32 s31, s31, 1
    s_lshl_b32 s31, s31, 5
    s_add_u32 s30, s30, s31
    s_add_u32 s30, s30, 0x980000
    v_lshlrev_b32 v14, 2, v1
    s_lshl_b32 s29, s24, 16
    s_lshl_b32 s31, s25, 10
    s_add_u32 s27, s29, s31
    s_lshl_b32 s32, s20, 11
    s_add_u32 s32, s32, 0x8000
    v_add_u32 v12, s32, v6
    v_xor_b32 v13, 0x800, v12
    s_mov_b64 exec, 0xff
    s_mov_b32 s28, 16384
Lp31:
    buffer_load_dword v15, v14, s[16:19], s30 offen sc1
    s_sub_u32 s28, s28, 1
    s_cbranch_scc1 Lok32
    s_waitcnt vmcnt(0)
    v_cmp_ne_u32 vcc, 0x01010101, v15
    s_cbranch_vccnz Lp31
Lok32:
    s_waitcnt vmcnt(0)
    s_mov_b64 exec, -1
    buffer_load_dwordx2 v[32:33], v7, s[16:19], s27 offen offset:0 sc1
    buffer_load_dwordx2 v[34:35], v7, s[16:19], s27 offen offset:512 sc1
    buffer_load_dwordx2 v[36:37], v7, s[16:19], s27 offen offset:2048 sc1
    buffer_load_dwordx2 v[38:39], v7, s[16:19], s27 offen offset:2560 sc1
    s_add_u32 s27, s27, 4096
    buffer_load_dwordx2 v[40:41], v7, s[16:19], s27 offen offset:0 sc1
    buffer_load_dwordx2 v[42:43], v7, s[16:19], s27 offen offset:512 sc1
    buffer_load_dwordx2 v[44:45], v7, s[16:19], s27 offen offset:2048 sc1
    buffer_load_dwordx2 v[46:47], v7, s[16:19], s27 offen offset:2560 sc1
    s_add_u32 s27, s27, 4096
    buffer_load_dwordx2 v[48:49], v7, s[16:19], s27 offen offset:0 sc1
    buffer_load_dwordx2 v[50:51], v7, s[16:19], s27 offen offset:512 sc1
    buffer_load_dwordx2 v[52:53], v7, s[16:19], s27 offen offset:2048 sc1
    buffer_load_dwordx2 v[54:55], v7, s[16:19], s27 offen offset:2560 sc1
    s_add_u32 s27, s27, 4096
    buffer_load_dwordx2 v[56:57], v7, s[16:19], s27 offen offset:0 sc1
    buffer_load_dwordx2 v[58:59], v7, s[16:19], s27 offen offset:512 sc1
    buffer_load_dwordx2 v[60:61], v7, s[16:19], s27 offen offset:2048 sc1
    buffer_load_dwordx2 v[62:63], v7, s[16:19], s27 offen offset:2560 sc1
    s_lshl_b32 s31, s22, 4
    s_add_u32 s28, s29, s31
    s_lshl_b32 s31, s25, 10
    s_add_u32 s28, s28, s31
    s_add_u32 s28, s28, 0xac00
    v_lshlrev_b32 v14, 4, v3
    s_lshr_b32 s31, s22, 7
    s_and_b32 s26, s31, 1
    s_lshl_b32 s26, s26, 10
    s_add_u32 s29, s29, s26
    s_lshr_b32 s31, s31, 1
    s_lshl_b32 s31, s31, 8
    s_add_u32 s29, s29, s31
    s_lshl_b32 s31, s25, 3
    s_add_u32 s29, s29, s31
    s_add_u32 s29, s29, 0xec00
    s_waitcnt vmcnt(14) lgkmcnt(0)
    v_mfma_f32_16x16x32_bf16 v[24:27], v[72:75], v[32:35], 0
    v_mfma_f32_16x16x32_bf16 v[28:31], v[76:79], v[32:35], 0
    v_mfma_f32_16x16x32_bf16 v[16:19], v[64:67], v[32:35], 0
    v_mfma_f32_16x16x32_bf16 v[20:23], v[68:71], v[32:35], 0
    ds_read_b64_tr_b16 v[64:65], v8 offset:49152
    ds_read_b64_tr_b16 v[66:67], v8 offset:51200
    ds_read_b64_tr_b16 v[68:69], v9 offset:49152
    ds_read_b64_tr_b16 v[70:71], v9 offset:51200
    ds_read_b64_tr_b16 v[72:73], v10 offset:49152
    ds_read_b64_tr_b16 v[74:75], v10 offset:51200
    ds_read_b64_tr_b16 v[76:77], v11 offset:49152
    ds_read_b64_tr_b16 v[78:79], v11 offset:51200
    s_waitcnt vmcnt(12)
    v_mfma_f32_16x16x32_bf16 v[24:27], v[88:91], v[36:39], v[24:27]
    v_mfma_f32_16x16x32_bf16 v[28:31], v[92:95], v[36:39], v[28:31]
    v_mfma_f32_16x16x32_bf16 v[16:19], v[80:83], v[36:39], v[16:19]
    v_mfma_f32_16x16x32_bf16 v[20:23], v[84:87], v[36:39], v[20:23]
    ds_read_b64_tr_b16 v[80:81], v8 offset:57344
    ds_read_b64_tr_b16 v[82:83], v8 offset:59392
    ds_read_b64_tr_b16 v[84:85], v9 offset:57344
    ds_read_b64_tr_b16 v[86:87], v9 offset:59392
    ds_read_b64_tr_b16 v[88:89], v10 offset:57344
    ds_read_b64_tr_b16 v[90:91], v10 offset:59392
    ds_read_b64_tr_b16 v[92:93], v11 offset:57344
    ds_read_b64_tr_b16 v[94:95], v11 offset:59392
    s_waitcnt vmcnt(10)
    v_mfma_f32_16x16x32_bf16 v[24:27], v[104:107], v[40:43], v[24:27]
    v_mfma_f32_16x16x32_bf16 v[28:31], v[108:111], v[40:43], v[28:31]
    v_mfma_f32_16x16x32_bf16 v[16:19], v[96:99], v[40:43], v[16:19]
    v_mfma_f32_16x16x32_bf16 v[20:23], v[100:103], v[40:43], v[20:23]
    s_waitcnt vmcnt(8)
    v_mfma_f32_16x16x32_bf16 v[24:27], v[120:123], v[44:47], v[24:27]
    v_mfma_f32_16x16x32_bf16 v[28:31], v[124:127], v[44:47], v[28:31]
    v_mfma_f32_16x16x32_bf16 v[16:19], v[112:115], v[44:47], v[16:19]
    v_mfma_f32_16x16x32_bf16 v[20:23], v[116:119], v[44:47], v[20:23]
    s_waitcnt vmcnt(6)
    v_mfma_f32_16x16x32_bf16 v[24:27], v[136:139], v[48:51], v[24:27]
    v_mfma_f32_16x16x32_bf16 v[28:31], v[140:143], v[48:51], v[28:31]
    v_mfma_f32_16x16x32_bf16 v[16:19], v[128:131], v[48:51], v[16:19]
    v_mfma_f32_16x16x32_bf16 v[20:23], v[132:135], v[48:51], v[20:23]
    s_waitcnt vmcnt(4)
    v_mfma_f32_16x16x32_bf16 v[24:27], v[152:155], v[52:55], v[24:27]
    v_mfma_f32_16x16x32_bf16 v[28:31], v[156:159], v[52:55], v[28:31]
    v_mfma_f32_16x16x32_bf16 v[16:19], v[144:147], v[52:55], v[16:19]
    v_mfma_f32_16x16x32_bf16 v[20:23], v[148:151], v[52:55], v[20:23]
    s_waitcnt vmcnt(2) lgkmcnt(8)
    v_mfma_f32_16x16x32_bf16 v[24:27], v[72:75], v[56:59], v[24:27]
    v_mfma_f32_16x16x32_bf16 v[28:31], v[76:79], v[56:59], v[28:31]
    v_mfma_f32_16x16x32_bf16 v[16:19], v[64:67], v[56:59], v[16:19]
    v_mfma_f32_16x16x32_bf16 v[20:23], v[68:71], v[56:59], v[20:23]
    s_waitcnt vmcnt(0) lgkmcnt(0)
    v_mfma_f32_16x16x32_bf16 v[24:27], v[88:91], v[60:63], v[24:27]
    v_mfma_f32_16x16x32_bf16 v[28:31], v[92:95], v[60:63], v[28:31]
    v_mfma_f32_16x16x32_bf16 v[16:19], v[80:83], v[60:63], v[16:19]
    v_mfma_f32_16x16x32_bf16 v[20:23], v[84:87], v[60:63], v[20:23]
    s_nop 4
    ds_write_b128 v12, v[24:27] offset:0
    ds_write_b128 v12, v[28:31] offset:1024
    v_lshlrev_b32 v40, 16, v164
    v_and_b32 v41, 0xffff0000, v164
    v_lshlrev_b32 v42, 16, v165
    v_and_b32 v43, 0xffff0000, v165
    v_lshlrev_b32 v44, 16, v166
    v_and_b32 v45, 0xffff0000, v166
    v_lshlrev_b32 v46, 16, v167
    v_and_b32 v47, 0xffff0000, v167
    v_mov_b32 v52, 0x3f803f80
    s_waitcnt lgkmcnt(0)
    s_barrier
    ds_read_b128 v[32:35], v13 offset:0
    ds_read_b128 v[36:39], v13 offset:1024
    s_waitcnt lgkmcnt(1)
    v_add_f32 v16, v16, v32
    v_add_f32 v17, v17, v33
    v_add_f32 v18, v18, v34
    v_add_f32 v19, v19, v35
    s_waitcnt lgkmcnt(0)
    v_add_f32 v20, v20, v36
    v_add_f32 v21, v21, v37
    v_add_f32 v22, v22, v38
    v_add_f32 v23, v23, v39
    v_add_f32 v40, v40, v16
    v_add_f32 v41, v41, v17
    v_add_f32 v42, v42, v18
    v_add_f32 v43, v43, v19
    v_add_f32 v44, v44, v20
    v_add_f32 v45, v45, v21
    v_add_f32 v46, v46, v22
    v_add_f32 v47, v47, v23
    v_cvt_pk_bf16_f32 v160, v40, v41
    v_cvt_pk_bf16_f32 v161, v42, v43
    v_cvt_pk_bf16_f32 v162, v44, v45
    v_cvt_pk_bf16_f32 v163, v46, v47
    s_cmp_eq_u32 s3, 0
    s_cbranch_scc1 Ls33
    buffer_store_dwordx4 v[160:163], v6, s[16:19], s28 offen
    s_branch Le34
Ls33:
    buffer_store_dwordx4 v[160:163], v6, s[16:19], s28 offen sc1
Le34:
    v_dot2_f32_bf16 v54, v160, v52, 0
    v_dot2_f32_bf16 v55, v160, v160, 0
    v_dot2_f32_bf16 v54, v161, v52, v54
    v_dot2_f32_bf16 v55, v161, v161, v55
    v_dot2_f32_bf16 v54, v162, v52, v54
    v_dot2_f32_bf16 v55, v162, v162, v55
    v_dot2_f32_bf16 v54, v163, v52, v54
    v_dot2_f32_bf16 v55, v163, v163, v55
    s_nop 1
    v_mov_b32 v52, v54
    v_mov_b32 v53, v55
    s_nop 0
    v_permlane16_swap_b32 v54, v52
    v_permlane16_swap_b32 v55, v53
    v_add_f32 v54, v54, v52
    v_add_f32 v55, v55, v53
    v_mov_b32 v52, v54
    v_mov_b32 v53, v55
    s_nop 0
    v_permlane32_swap_b32 v54, v52
    v_permlane32_swap_b32 v55, v53
    v_add_f32 v54, v54, v52
    v_add_f32 v55, v55, v53
    s_cmp_eq_u32 s3, 0
    s_cbranch_scc1 Ls35
    buffer_store_dwordx2 v[54:55], v14, s[16:19], s29 offen
    s_branch Le36
Ls35:
    buffer_store_dwordx2 v[54:55], v14, s[16:19], s29 offen sc1
Le36:
    v_mov_b32 v56, 1
    v_mov_b32 v57, 0
    s_waitcnt vmcnt(0)
    s_mov_b64 exec, 1
    s_cmp_eq_u32 s3, 0
    s_cbranch_scc1 Ls37
    buffer_store_byte v56, v57, s[16:19], s1 offen
    s_branch Le38
Ls37:
    buffer_store_byte v56, v57, s[16:19], s1 offen sc1
Le38:
    s_mov_b64 exec, -1
    s_and_b32 s30, s2, 7
    s_lshr_b32 s31, s2, 3
    s_lshl_b32 s21, s30, 1
    s_and_b32 s22, s31, 1
    s_add_u32 s33, s21, s22
    s_lshr_b32 s34, s31, 1
    s_lshl_b32 s21, s33, 7
    s_min_u32 s22, s34, 14
    s_mul_i32 s22, s22, 192
    s_lshl_b32 s23, s20, 4
    s_add_u32 s24, s21, s23
    s_xor_b32 s37, s24, 16
    s_and_b32 s36, s20, 1
    v_lshlrev_b32 v46, 3, v2
    s_lshl_b32 s30, s36, 5
    s_add_u32 s30, s30, s22
    buffer_load_dwordx2 v[120:121], v46, s[52:55], s30 offen offset:0
    buffer_load_dwordx2 v[122:123], v46, s[52:55], s30 offen offset:64
    buffer_load_dwordx2 v[124:125], v46, s[52:55], s30 offen offset:128
    v_lshl_add_u32 v8, v2, 2, v4
    v_lshlrev_b32 v8, 6, v8
    v_lshl_add_u32 v8, v5, 3, v8
    v_and_b32 v15, 1, v2
    v_lshlrev_b32 v15, 5, v15
    s_sub_u32 s26, s20, 6
    s_cmp_lt_u32 s20, 6
    s_cselect_b32 s26, s20, s26
    s_lshr_b32 s27, s26, 1
    s_lshl_b32 s27, s27, 11
    s_lshl_b32 s28, s36, 5
    v_xor_b32 v15, s28, v15
    v_add_u32 v8, v8, v15
    v_add_u32 v11, s27, v8
    s_lshl_b32 s35, s20, 10
    v_add_u32 v40, s35, v6
    v_xor_b32 v43, 0x400, v40
    v_add_u32 v9, 0xe000, v8
    v_add_u32 v12, 0xe000, v11
    v_add_u32 v41, 0xe000, v40
    v_add_u32 v44, 0xe000, v43
    v_add_u32 v10, 0x1c000, v8
    v_add_u32 v13, 0x1c000, v11
    v_add_u32 v42, 0x1c000, v40
    v_add_u32 v45, 0x1c000, v43
    v_mov_b32 v16, 0x3f803f80
    v_mov_b32 v17, 0x3f803f80
    v_mov_b32 v18, 0x3f803f80
    v_mov_b32 v19, 0x3f803f80
    s_waitcnt lgkmcnt(0)
    s_barrier
    ds_read_b128 v[48:51], v41 offset:16384
    ds_read_b64_tr_b16 v[56:57], v8 offset:0
    ds_read_b64_tr_b16 v[58:59], v8 offset:1024
    ds_read_b64_tr_b16 v[60:61], v8 offset:2048
    ds_read_b64_tr_b16 v[62:63], v8 offset:3072
    ds_read_b128 v[52:55], v44 offset:16384
    ds_read_b64_tr_b16 v[64:65], v8 offset:4096
    ds_read_b64_tr_b16 v[66:67], v8 offset:5120
    ds_read_b64_tr_b16 v[68:69], v11 offset:0
    ds_read_b64_tr_b16 v[70:71], v11 offset:1024
    s_barrier
    ds_read_b128 v[72:75], v41 offset:24576
    ds_read_b64_tr_b16 v[80:81], v8 offset:6144
    ds_read_b64_tr_b16 v[82:83], v8 offset:7168
    ds_read_b64_tr_b16 v[84:85], v8 offset:8192
    ds_read_b64_tr_b16 v[86:87], v8 offset:9216
    ds_read_b128 v[76:79], v44 offset:24576
    ds_read_b64_tr_b16 v[88:89], v8 offset:10240
    ds_read_b64_tr_b16 v[90:91], v8 offset:11264
    ds_read_b64_tr_b16 v[92:93], v11 offset:6144
    ds_read_b64_tr_b16 v[94:95], v11 offset:7168
    s_waitcnt lgkmcnt(10)
    v_mfma_f32_16x16x32_bf16 v[96:99], v[56:59], v[48:51], 0
    s_barrier
    ds_read_b128 v[132:135], v41 offset:32768
    ds_read_b64_tr_b16 v[140:141], v8 offset:12288
    v_mfma_f32_16x16x32_bf16 v[100:103], v[60:63], v[48:51], 0
    ds_read_b64_tr_b16 v[142:143], v8 offset:13312
    ds_read_b64_tr_b16 v[144:145], v8 offset:14336
    v_mfma_f32_16x16x32_bf16 v[104:107], v[64:67], v[48:51], 0
    ds_read_b64_tr_b16 v[146:147], v8 offset:15360
    ds_read_b128 v[136:139], v44 offset:32768
    v_mfma_f32_16x16x32_bf16 v[108:111], v[56:59], v[52:55], 0
    ds_read_b64_tr_b16 v[148:149], v8 offset:16384
    ds_read_b64_tr_b16 v[150:151], v8 offset:17408
    v_mfma_f32_16x16x32_bf16 v[112:115], v[60:63], v[52:55], 0
    ds_read_b64_tr_b16 v[152:153], v11 offset:12288
    ds_read_b64_tr_b16 v[154:155], v11 offset:13312
    v_mfma_f32_16x16x32_bf16 v[116:119], v[64:67], v[52:55], 0
    v_mfma_f32_16x16x32_bf16 v[128:131], v[68:71], v[16:19], 0
    s_waitcnt lgkmcnt(10)
    v_mfma_f32_16x16x32_bf16 v[96:99], v[80:83], v[72:75], v[96:99]
    ds_read_b128 v[48:51], v41 offset:40960
    ds_read_b64_tr_b16 v[56:57], v8 offset:18432
    v_mfma_f32_16x16x32_bf16 v[100:103], v[84:87], v[72:75], v[100:103]
    ds_read_b64_tr_b16 v[58:59], v8 offset:19456
    ds_read_b64_tr_b16 v[60:61], v8 offset:20480
    v_mfma_f32_16x16x32_bf16 v[104:107], v[88:91], v[72:75], v[104:107]
    ds_read_b64_tr_b16 v[62:63], v8 offset:21504
    ds_read_b128 v[52:55], v44 offset:40960
    v_mfma_f32_16x16x32_bf16 v[108:111], v[80:83], v[76:79], v[108:111]
    ds_read_b64_tr_b16 v[64:65], v8 offset:22528
    ds_read_b64_tr_b16 v[66:67], v8 offset:23552
    v_mfma_f32_16x16x32_bf16 v[112:115], v[84:87], v[76:79], v[112:115]
    ds_read_b64_tr_b16 v[68:69], v11 offset:18432
    ds_read_b64_tr_b16 v[70:71], v11 offset:19456
    v_mfma_f32_16x16x32_bf16 v[116:119], v[88:91], v[76:79], v[116:119]
    v_mfma_f32_16x16x32_bf16 v[128:131], v[92:95], v[16:19], v[128:131]
    s_waitcnt lgkmcnt(10)
    v_mfma_f32_16x16x32_bf16 v[96:99], v[140:143], v[132:135], v[96:99]
    s_barrier
    ds_read_b128 v[72:75], v41 offset:49152
    ds_read_b64_tr_b16 v[80:81], v8 offset:24576
    v_mfma_f32_16x16x32_bf16 v[100:103], v[144:147], v[132:135], v[100:103]
    ds_read_b64_tr_b16 v[82:83], v8 offset:25600
    ds_read_b64_tr_b16 v[84:85], v8 offset:26624
    v_mfma_f32_16x16x32_bf16 v[104:107], v[148:151], v[132:135], v[104:107]
    ds_read_b64_tr_b16 v[86:87], v8 offset:27648
    ds_read_b128 v[76:79], v44 offset:49152
    v_mfma_f32_16x16x32_bf16 v[108:111], v[140:143], v[136:139], v[108:111]
    ds_read_b64_tr_b16 v[88:89], v8 offset:28672
    ds_read_b64_tr_b16 v[90:91], v8 offset:29696
    v_mfma_f32_16x16x32_bf16 v[112:115], v[144:147], v[136:139], v[112:115]
    ds_read_b64_tr_b16 v[92:93], v11 offset:24576
    ds_read_b64_tr_b16 v[94:95], v11 offset:25600
    v_mfma_f32_16x16x32_bf16 v[116:119], v[148:151], v[136:139], v[116:119]
    v_mfma_f32_16x16x32_bf16 v[128:131], v[152:155], v[16:19], v[128:131]
    s_waitcnt lgkmcnt(10)
    v_mfma_f32_16x16x32_bf16 v[96:99], v[56:59], v[48:51], v[96:99]
    ds_read_b128 v[132:135], v42 offset:0
    ds_read_b64_tr_b16 v[140:141], v8 offset:49152
    v_mfma_f32_16x16x32_bf16 v[100:103], v[60:63], v[48:51], v[100:103]
    ds_read_b64_tr_b16 v[142:143], v8 offset:50176
    ds_read_b64_tr_b16 v[144:145], v8 offset:51200
    v_mfma_f32_16x16x32_bf16 v[104:107], v[64:67], v[48:51], v[104:107]
    ds_read_b64_tr_b16 v[146:147], v8 offset:52224
    ds_read_b128 v[136:139], v45 offset:0
    v_mfma_f32_16x16x32_bf16 v[108:111], v[56:59], v[52:55], v[108:111]
    ds_read_b64_tr_b16 v[148:149], v8 offset:53248
    ds_read_b64_tr_b16 v[150:151], v8 offset:54272
    v_mfma_f32_16x16x32_bf16 v[112:115], v[60:63], v[52:55], v[112:115]
    ds_read_b64_tr_b16 v[152:153], v11 offset:49152
    ds_read_b64_tr_b16 v[154:155], v11 offset:50176
    v_mfma_f32_16x16x32_bf16 v[116:119], v[64:67], v[52:55], v[116:119]
    v_mfma_f32_16x16x32_bf16 v[128:131], v[68:71], v[16:19], v[128:131]
    s_waitcnt lgkmcnt(10)
    v_mfma_f32_16x16x32_bf16 v[96:99], v[80:83], v[72:75], v[96:99]
    s_barrier
    ds_read_b128 v[48:51], v42 offset:8192
    ds_read_b64_tr_b16 v[56:57], v8 offset:55296
    v_mfma_f32_16x16x32_bf16 v[100:103], v[84:87], v[72:75], v[100:103]
    ds_read_b64_tr_b16 v[58:59], v8 offset:56320
    ds_read_b64_tr_b16 v[60:61], v8 offset:57344
    v_mfma_f32_16x16x32_bf16 v[104:107], v[88:91], v[72:75], v[104:107]
    ds_read_b64_tr_b16 v[62:63], v8 offset:58368
    ds_read_b128 v[52:55], v45 offset:8192
    v_mfma_f32_16x16x32_bf16 v[108:111], v[80:83], v[76:79], v[108:111]
    ds_read_b64_tr_b16 v[64:65], v8 offset:59392
    ds_read_b64_tr_b16 v[66:67], v8 offset:60416
    v_mfma_f32_16x16x32_bf16 v[112:115], v[84:87], v[76:79], v[112:115]
    ds_read_b64_tr_b16 v[68:69], v11 offset:55296
    ds_read_b64_tr_b16 v[70:71], v11 offset:56320
    v_mfma_f32_16x16x32_bf16 v[116:119], v[88:91], v[76:79], v[116:119]
    v_mfma_f32_16x16x32_bf16 v[128:131], v[92:95], v[16:19], v[128:131]
    s_waitcnt lgkmcnt(10)
    v_mfma_f32_16x16x32_bf16 v[96:99], v[140:143], v[132:135], v[96:99]
    ds_read_b128 v[72:75], v42 offset:16384
    ds_read_b64_tr_b16 v[80:81], v9 offset:4096
    v_mfma_f32_16x16x32_bf16 v[100:103], v[144:147], v[132:135], v[100:103]
    ds_read_b64_tr_b16 v[82:83], v9 offset:5120
    ds_read_b64_tr_b16 v[84:85], v9 offset:6144
    v_mfma_f32_16x16x32_bf16 v[104:107], v[148:151], v[132:135], v[104:107]
    ds_read_b64_tr_b16 v[86:87], v9 offset:7168
    ds_read_b128 v[76:79], v45 offset:16384
    v_mfma_f32_16x16x32_bf16 v[108:111], v[140:143], v[136:139], v[108:111]
    ds_read_b64_tr_b16 v[88:89], v9 offset:8192
    ds_read_b64_tr_b16 v[90:91], v9 offset:9216
    v_mfma_f32_16x16x32_bf16 v[112:115], v[144:147], v[136:139], v[112:115]
    ds_read_b64_tr_b16 v[92:93], v12 offset:4096
    ds_read_b64_tr_b16 v[94:95], v12 offset:5120
    v_mfma_f32_16x16x32_bf16 v[116:119], v[148:151], v[136:139], v[116:119]
    v_mfma_f32_16x16x32_bf16 v[128:131], v[152:155], v[16:19], v[128:131]
    s_waitcnt lgkmcnt(10)
    v_mfma_f32_16x16x32_bf16 v[96:99], v[56:59], v[48:51], v[96:99]
    s_barrier
    ds_read_b128 v[132:135], v41 offset:16384
    ds_read_b64_tr_b16 v[140:141], v9 offset:10240
    v_mfma_f32_16x16x32_bf16 v[100:103], v[60:63], v[48:51], v[100:103]
    ds_read_b64_tr_b16 v[142:143], v9 offset:11264
    ds_read_b64_tr_b16 v[144:145], v9 offset:12288
    v_mfma_f32_16x16x32_bf16 v[104:107], v[64:67], v[48:51], v[104:107]
    ds_read_b64_tr_b16 v[146:147], v9 offset:13312
    ds_read_b128 v[136:139], v44 offset:16384
    v_mfma_f32_16x16x32_bf16 v[108:111], v[56:59], v[52:55], v[108:111]
    ds_read_b64_tr_b16 v[148:149], v9 offset:14336
    ds_read_b64_tr_b16 v[150:151], v9 offset:15360
    v_mfma_f32_16x16x32_bf16 v[112:115], v[60:63], v[52:55], v[112:115]
    ds_read_b64_tr_b16 v[152:153], v12 offset:10240
    ds_read_b64_tr_b16 v[154:155], v12 offset:11264
    v_mfma_f32_16x16x32_bf16 v[116:119], v[64:67], v[52:55], v[116:119]
    v_mfma_f32_16x16x32_bf16 v[128:131], v[68:71], v[16:19], v[128:131]
    s_lshl_b32 s30, s24, 12
    s_add_u32 s30, s30, 0xec00
    buffer_load_dwordx4 v[20:23], v6, s[16:19], s30 offen offset:0 sc1
    buffer_load_dwordx4 v[24:27], v6, s[16:19], s30 offen offset:1024 sc1
    s_lshl_b32 s30, s37, 12
    s_add_u32 s30, s30, 0xec00
    buffer_load_dwordx4 v[28:31], v6, s[16:19], s30 offen offset:0 sc1
    buffer_load_dwordx4 v[32:35], v6, s[16:19], s30 offen offset:1024 sc1
    s_waitcnt lgkmcnt(10)
    v_mfma_f32_16x16x32_bf16 v[96:99], v[80:83], v[72:75], v[96:99]
    ds_read_b128 v[48:51], v41 offset:24576
    ds_read_b64_tr_b16 v[56:57], v10 offset:36864
    v_mfma_f32_16x16x32_bf16 v[100:103], v[84:87], v[72:75], v[100:103]
    ds_read_b64_tr_b16 v[58:59], v10 offset:37888
    ds_read_b64_tr_b16 v[60:61], v10 offset:38912
    v_mfma_f32_16x16x32_bf16 v[104:107], v[88:91], v[72:75], v[104:107]
    ds_read_b64_tr_b16 v[62:63], v10 offset:39936
    ds_read_b128 v[52:55], v44 offset:24576
    v_mfma_f32_16x16x32_bf16 v[108:111], v[80:83], v[76:79], v[108:111]
    ds_read_b64_tr_b16 v[64:65], v10 offset:40960
    ds_read_b64_tr_b16 v[66:67], v10 offset:41984
    v_mfma_f32_16x16x32_bf16 v[112:115], v[84:87], v[76:79], v[112:115]
    ds_read_b64_tr_b16 v[68:69], v13 offset:36864
    ds_read_b64_tr_b16 v[70:71], v13 offset:37888
    v_mfma_f32_16x16x32_bf16 v[116:119], v[88:91], v[76:79], v[116:119]
    v_mfma_f32_16x16x32_bf16 v[128:131], v[92:95], v[16:19], v[128:131]
    s_waitcnt lgkmcnt(10)
    v_mfma_f32_16x16x32_bf16 v[96:99], v[140:143], v[132:135], v[96:99]
    s_barrier
    ds_read_b128 v[72:75], v41 offset:32768
    ds_read_b64_tr_b16 v[80:81], v10 offset:24576
    v_mfma_f32_16x16x32_bf16 v[100:103], v[144:147], v[132:135], v[100:103]
    ds_read_b64_tr_b16 v[82:83], v10 offset:25600
    ds_read_b64_tr_b16 v[84:85], v10 offset:26624
    v_mfma_f32_16x16x32_bf16 v[104:107], v[148:151], v[132:135], v[104:107]
    ds_read_b64_tr_b16 v[86:87], v10 offset:27648
    ds_read_b128 v[76:79], v44 offset:32768
    v_mfma_f32_16x16x32_bf16 v[108:111], v[140:143], v[136:139], v[108:111]
    ds_read_b64_tr_b16 v[88:89], v10 offset:28672
    ds_read_b64_tr_b16 v[90:91], v10 offset:29696
    v_mfma_f32_16x16x32_bf16 v[112:115], v[144:147], v[136:139], v[112:115]
    ds_read_b64_tr_b16 v[92:93], v13 offset:24576
    ds_read_b64_tr_b16 v[94:95], v13 offset:25600
    v_mfma_f32_16x16x32_bf16 v[116:119], v[148:151], v[136:139], v[116:119]
    v_mfma_f32_16x16x32_bf16 v[128:131], v[152:155], v[16:19], v[128:131]
    s_waitcnt lgkmcnt(10)
    v_mfma_f32_16x16x32_bf16 v[96:99], v[56:59], v[48:51], v[96:99]
    ds_read_b128 v[132:135], v41 offset:40960
    ds_read_b64_tr_b16 v[140:141], v10 offset:30720
    v_mfma_f32_16x16x32_bf16 v[100:103], v[60:63], v[48:51], v[100:103]
    ds_read_b64_tr_b16 v[142:143], v10 offset:31744
    ds_read_b64_tr_b16 v[144:145], v10 offset:32768
    v_mfma_f32_16x16x32_bf16 v[104:107], v[64:67], v[48:51], v[104:107]
    ds_read_b64_tr_b16 v[146:147], v10 offset:33792
    ds_read_b128 v[136:139], v44 offset:40960
    v_mfma_f32_16x16x32_bf16 v[108:111], v[56:59], v[52:55], v[108:111]
    ds_read_b64_tr_b16 v[148:149], v10 offset:34816
    ds_read_b64_tr_b16 v[150:151], v10 offset:35840
    v_mfma_f32_16x16x32_bf16 v[112:115], v[60:63], v[52:55], v[112:115]
    ds_read_b64_tr_b16 v[152:153], v13 offset:30720
    ds_read_b64_tr_b16 v[154:155], v13 offset:31744
    v_mfma_f32_16x16x32_bf16 v[116:119], v[64:67], v[52:55], v[116:119]
    v_mfma_f32_16x16x32_bf16 v[128:131], v[68:71], v[16:19], v[128:131]
    s_waitcnt lgkmcnt(10)
    v_mfma_f32_16x16x32_bf16 v[96:99], v[80:83], v[72:75], v[96:99]
    s_barrier
    ds_read_b128 v[48:51], v41 offset:49152
    ds_read_b64_tr_b16 v[56:57], v8 offset:30720
    v_mfma_f32_16x16x32_bf16 v[100:103], v[84:87], v[72:75], v[100:103]
    ds_read_b64_tr_b16 v[58:59], v8 offset:31744
    ds_read_b64_tr_b16 v[60:61], v8 offset:32768
    v_mfma_f32_16x16x32_bf16 v[104:107], v[88:91], v[72:75], v[104:107]
    ds_read_b64_tr_b16 v[62:63], v8 offset:33792
    ds_read_b128 v[52:55], v44 offset:49152
    v_mfma_f32_16x16x32_bf16 v[108:111], v[80:83], v[76:79], v[108:111]
    ds_read_b64_tr_b16 v[64:65], v8 offset:34816
    ds_read_b64_tr_b16 v[66:67], v8 offset:35840
    v_mfma_f32_16x16x32_bf16 v[112:115], v[84:87], v[76:79], v[112:115]
    ds_read_b64_tr_b16 v[68:69], v11 offset:30720
    ds_read_b64_tr_b16 v[70:71], v11 offset:31744
    v_mfma_f32_16x16x32_bf16 v[116:119], v[88:91], v[76:79], v[116:119]
    v_mfma_f32_16x16x32_bf16 v[128:131], v[92:95], v[16:19], v[128:131]
    s_waitcnt lgkmcnt(10)
    v_mfma_f32_16x16x32_bf16 v[96:99], v[140:143], v[132:135], v[96:99]
    ds_read_b128 v[72:75], v42 offset:0
    ds_read_b64_tr_b16 v[80:81], v8 offset:36864
    v_mfma_f32_16x16x32_bf16 v[100:103], v[144:147], v[132:135], v[100:103]
    ds_read_b64_tr_b16 v[82:83], v8 offset:37888
    ds_read_b64_tr_b16 v[84:85], v8 offset:38912
    v_mfma_f32_16x16x32_bf16 v[104:107], v[148:151], v[132:135], v[104:107]
    ds_read_b64_tr_b16 v[86:87], v8 offset:39936
    ds_read_b128 v[76:79], v45 offset:0
    v_mfma_f32_16x16x32_bf16 v[108:111], v[140:143], v[136:139], v[108:111]
    ds_read_b64_tr_b16 v[88:89], v8 offset:40960
    ds_read_b64_tr_b16 v[90:91], v8 offset:41984
    v_mfma_f32_16x16x32_bf16 v[112:115], v[144:147], v[136:139], v[112:115]
    ds_read_b64_tr_b16 v[92:93], v11 offset:36864
    ds_read_b64_tr_b16 v[94:95], v11 offset:37888
    v_mfma_f32_16x16x32_bf16 v[116:119], v[148:151], v[136:139], v[116:119]
    v_mfma_f32_16x16x32_bf16 v[128:131], v[152:155], v[16:19], v[128:131]
    s_waitcnt lgkmcnt(10)
    v_mfma_f32_16x16x32_bf16 v[96:99], v[56:59], v[48:51], v[96:99]
    s_barrier
    ds_read_b128 v[132:135], v42 offset:8192
    ds_read_b64_tr_b16 v[140:141], v8 offset:43008
    v_mfma_f32_16x16x32_bf16 v[100:103], v[60:63], v[48:51], v[100:103]
    ds_read_b64_tr_b16 v[142:143], v8 offset:44032
    ds_read_b64_tr_b16 v[144:145], v8 offset:45056
    v_mfma_f32_16x16x32_bf16 v[104:107], v[64:67], v[48:51], v[104:107]
    ds_read_b64_tr_b16 v[146:147], v8 offset:46080
    ds_read_b128 v[136:139], v45 offset:8192
    v_mfma_f32_16x16x32_bf16 v[108:111], v[56:59], v[52:55], v[108:111]
    ds_read_b64_tr_b16 v[148:149], v8 offset:47104
    ds_read_b64_tr_b16 v[150:151], v8 offset:48128
    v_mfma_f32_16x16x32_bf16 v[112:115], v[60:63], v[52:55], v[112:115]
    ds_read_b64_tr_b16 v[152:153], v11 offset:43008
    ds_read_b64_tr_b16 v[154:155], v11 offset:44032
    v_mfma_f32_16x16x32_bf16 v[116:119], v[64:67], v[52:55], v[116:119]
    v_mfma_f32_16x16x32_bf16 v[128:131], v[68:71], v[16:19], v[128:131]
    s_waitcnt lgkmcnt(10)
    v_mfma_f32_16x16x32_bf16 v[96:99], v[80:83], v[72:75], v[96:99]
    ds_read_b128 v[48:51], v42 offset:16384
    ds_read_b64_tr_b16 v[56:57], v8 offset:0
    v_mfma_f32_16x16x32_bf16 v[100:103], v[84:87], v[72:75], v[100:103]
    ds_read_b64_tr_b16 v[58:59], v8 offset:1024
    ds_read_b64_tr_b16 v[60:61], v8 offset:2048
    v_mfma_f32_16x16x32_bf16 v[104:107], v[88:91], v[72:75], v[104:107]
    ds_read_b64_tr_b16 v[62:63], v8 offset:3072
    ds_read_b128 v[52:55], v45 offset:16384
    v_mfma_f32_16x16x32_bf16 v[108:111], v[80:83], v[76:79], v[108:111]
    ds_read_b64_tr_b16 v[64:65], v8 offset:4096
    ds_read_b64_tr_b16 v[66:67], v8 offset:5120
    v_mfma_f32_16x16x32_bf16 v[112:115], v[84:87], v[76:79], v[112:115]
    ds_read_b64_tr_b16 v[68:69], v11 offset:0
    ds_read_b64_tr_b16 v[70:71], v11 offset:1024
    v_mfma_f32_16x16x32_bf16 v[116:119], v[88:91], v[76:79], v[116:119]
    v_mfma_f32_16x16x32_bf16 v[128:131], v[92:95], v[16:19], v[128:131]
    s_waitcnt vmcnt(0)
    v_add_f32 v20, v20, v22
    v_add_f32 v21, v21, v23
    v_add_f32 v24, v24, v26
    v_add_f32 v25, v25, v27
    v_add_f32 v28, v28, v30
    v_add_f32 v29, v29, v31
    v_add_f32 v32, v32, v34
    v_add_f32 v33, v33, v35
    v_add_f32 v20, v20, v24
    v_add_f32 v21, v21, v25
    v_add_f32 v28, v28, v32
    v_add_f32 v29, v29, v33
    v_mov_b32 v22, v20
    v_mov_b32 v23, v21
    v_mov_b32 v30, v28
    v_mov_b32 v31, v29
    v_permlane16_swap_b32 v20, v22
    v_permlane16_swap_b32 v21, v23
    v_permlane16_swap_b32 v28, v30
    v_permlane16_swap_b32 v29, v31
    v_add_f32 v20, v20, v22
    v_add_f32 v21, v21, v23
    v_add_f32 v28, v28, v30
    v_add_f32 v29, v29, v31
    v_mov_b32 v22, v20
    v_mov_b32 v23, v21
    v_mov_b32 v30, v28
    v_mov_b32 v31, v29
    v_permlane32_swap_b32 v20, v22
    v_permlane32_swap_b32 v21, v23
    v_permlane32_swap_b32 v28, v30
    v_permlane32_swap_b32 v29, v31
    v_add_f32 v20, v20, v22
    v_add_f32 v21, v21, v23
    v_add_f32 v28, v28, v30
    v_add_f32 v29, v29, v31
    s_waitcnt lgkmcnt(10)
    v_mfma_f32_16x16x32_bf16 v[96:99], v[140:143], v[132:135], v[96:99]
    v_mfma_f32_16x16x32_bf16 v[100:103], v[144:147], v[132:135], v[100:103]
    v_mfma_f32_16x16x32_bf16 v[104:107], v[148:151], v[132:135], v[104:107]
    v_mfma_f32_16x16x32_bf16 v[108:111], v[140:143], v[136:139], v[108:111]
    v_mfma_f32_16x16x32_bf16 v[112:115], v[144:147], v[136:139], v[112:115]
    v_mfma_f32_16x16x32_bf16 v[116:119], v[148:151], v[136:139], v[116:119]
    v_mfma_f32_16x16x32_bf16 v[128:131], v[152:155], v[16:19], v[128:131]
    v_mul_f32 v20, 0x3b000000, v20
    v_mul_f32 v21, 0x3b000000, v21
    v_fma_f32 v21, -v20, v20, v21
    v_max_f32 v21, 0, v21
    v_cvt_pk_bf16_f32 v36, v20, v20
    v_lshlrev_b32 v36, 16, v36
    v_cvt_pk_bf16_f32 v21, v21, v21
    v_lshlrev_b32 v21, 16, v21
    v_add_f32 v21, 0x3727c5ac, v21
    v_cvt_pk_bf16_f32 v21, v21, v21
    v_lshlrev_b32 v21, 16, v21
    v_sqrt_f32 v21, v21
    s_nop 0
    v_cvt_pk_bf16_f32 v21, v21, v21
    v_lshlrev_b32 v21, 16, v21
    v_rcp_f32 v37, v21
    v_mul_f32 v28, 0x3b000000, v28
    v_mul_f32 v29, 0x3b000000, v29
    v_fma_f32 v29, -v28, v28, v29
    v_max_f32 v29, 0, v29
    v_cvt_pk_bf16_f32 v38, v28, v28
    v_lshlrev_b32 v38, 16, v38
    v_cvt_pk_bf16_f32 v29, v29, v29
    v_lshlrev_b32 v29, 16, v29
    v_add_f32 v29, 0x3727c5ac, v29
    v_cvt_pk_bf16_f32 v29, v29, v29
    v_lshlrev_b32 v29, 16, v29
    v_sqrt_f32 v29, v29
    s_nop 0
    v_cvt_pk_bf16_f32 v29, v29, v29
    v_lshlrev_b32 v29, 16, v29
    v_rcp_f32 v39, v29
    s_waitcnt lgkmcnt(0)
    v_mfma_f32_16x16x32_bf16 v[96:99], v[56:59], v[48:51], v[96:99]
    v_mfma_f32_16x16x32_bf16 v[100:103], v[60:63], v[48:51], v[100:103]
    v_mfma_f32_16x16x32_bf16 v[104:107], v[64:67], v[48:51], v[104:107]
    v_mfma_f32_16x16x32_bf16 v[108:111], v[56:59], v[52:55], v[108:111]
    v_mfma_f32_16x16x32_bf16 v[112:115], v[60:63], v[52:55], v[112:115]
    v_mfma_f32_16x16x32_bf16 v[116:119], v[64:67], v[52:55], v[116:119]
    v_mfma_f32_16x16x32_bf16 v[128:131], v[68:71], v[16:19], v[128:131]
    s_lshl_b32 s27, s36, 9
    s_mul_i32 s25, s34, 3 * 1024
    s_add_u32 s25, s25, s27
    s_lshl_b32 s28, s24, 12
    s_lshl_b32 s29, s37, 12
    v_and_b32 v22, 1, v2
    v_cmp_eq_u32 vcc, 0, v22
    v_mov_b32 v22, s28
    v_mov_b32 v23, s29
    v_cndmask_b32 v22, v23, v22, vcc
    v_lshrrev_b32 v23, 1, v2
    v_lshl_add_u32 v22, v23, 8, v22
    v_lshl_add_u32 v22, v3, 4, v22
    v_lshlrev_b32 v72, 16, v120
    v_and_b32 v73, 0xffff0000, v120
    v_lshlrev_b32 v74, 16, v121
    v_and_b32 v75, 0xffff0000, v121
    v_lshlrev_b32 v76, 16, v122
    v_and_b32 v77, 0xffff0000, v122
    v_lshlrev_b32 v78, 16, v123
    v_and_b32 v79, 0xffff0000, v123
    v_lshlrev_b32 v80, 16, v124
    v_and_b32 v81, 0xffff0000, v124
    v_lshlrev_b32 v82, 16, v125
    v_and_b32 v83, 0xffff0000, v125
    v_lshlrev_b32 v15, 4, v2
    s_lshl_b32 s27, s26, 6
    s_add_u32 s27, s27, 0x27000
    v_add_u32 v14, s27, v15
    ds_write_b128 v14, v[128:131]
    s_lshl_b32 s27, s36, 6
    s_add_u32 s27, s27, 0x27000
    v_add_u32 v15, s27, v15
    s_waitcnt lgkmcnt(0)
    s_barrier
    ds_read_b128 v[132:135], v15 offset:0
    ds_read_b128 v[136:139], v15 offset:128
    ds_read_b128 v[140:143], v15 offset:256
    s_cmp_eq_u32 s34, 15
    s_cbranch_scc1 k3_done
    s_waitcnt lgkmcnt(2)
    v_fma_f32 v96, -v36, v132, v96
    v_fma_f32 v97, -v36, v133, v97
    v_fma_f32 v98, -v36, v134, v98
    v_fma_f32 v99, -v36, v135, v99
    v_fma_f32 v108, -v38, v132, v108
    v_fma_f32 v109, -v38, v133, v109
    v_fma_f32 v110, -v38, v134, v110
    v_fma_f32 v111, -v38, v135, v111
    v_fma_f32 v96, v37, v96, v72
    v_fma_f32 v97, v37, v97, v73
    v_fma_f32 v98, v37, v98, v74
    v_fma_f32 v99, v37, v99, v75
    v_fma_f32 v108, v39, v108, v72
    v_fma_f32 v109, v39, v109, v73
    v_fma_f32 v110, v39, v110, v74
    v_fma_f32 v111, v39, v111, v75
    v_mul_f32 v96, v96, |v96|
    v_mul_f32 v97, v97, |v97|
    v_mul_f32 v98, v98, |v98|
    v_mul_f32 v99, v99, |v99|
    v_mul_f32 v108, v108, |v108|
    v_mul_f32 v109, v109, |v109|
    v_mul_f32 v110, v110, |v110|
    v_mul_f32 v111, v111, |v111|
    v_cvt_pk_bf16_f32 v144, v96, v97
    v_cvt_pk_bf16_f32 v145, v98, v99
    v_cvt_pk_bf16_f32 v146, v108, v109
    v_cvt_pk_bf16_f32 v147, v110, v111
    v_pk_max_i16 v144, v144, 0
    v_pk_max_i16 v145, v145, 0
    v_pk_max_i16 v146, v146, 0
    v_pk_max_i16 v147, v147, 0
    s_nop 0
    v_permlane16_swap_b32 v144, v146
    v_permlane16_swap_b32 v145, v147
    s_cmp_eq_u32 s3, 0
    s_cbranch_scc1 Ls39
    buffer_store_dwordx4 v[144:147], v22, s[16:19], s25 offen offset:0
    s_branch Le40
Ls39:
    buffer_store_dwordx4 v[144:147], v22, s[16:19], s25 offen offset:0 sc1
Le40:
    s_cmp_eq_u32 s34, 14
    s_cbranch_scc1 k3_done
    s_waitcnt lgkmcnt(1)
    v_fma_f32 v100, -v36, v136, v100
    v_fma_f32 v101, -v36, v137, v101
    v_fma_f32 v102, -v36, v138, v102
    v_fma_f32 v103, -v36, v139, v103
    v_fma_f32 v112, -v38, v136, v112
    v_fma_f32 v113, -v38, v137, v113
    v_fma_f32 v114, -v38, v138, v114
    v_fma_f32 v115, -v38, v139, v115
    v_fma_f32 v100, v37, v100, v76
    v_fma_f32 v101, v37, v101, v77
    v_fma_f32 v102, v37, v102, v78
    v_fma_f32 v103, v37, v103, v79
    v_fma_f32 v112, v39, v112, v76
    v_fma_f32 v113, v39, v113, v77
    v_fma_f32 v114, v39, v114, v78
    v_fma_f32 v115, v39, v115, v79
    v_mul_f32 v100, v100, |v100|
    v_mul_f32 v101, v101, |v101|
    v_mul_f32 v102, v102, |v102|
    v_mul_f32 v103, v103, |v103|
    v_mul_f32 v112, v112, |v112|
    v_mul_f32 v113, v113, |v113|
    v_mul_f32 v114, v114, |v114|
    v_mul_f32 v115, v115, |v115|
    v_cvt_pk_bf16_f32 v148, v100, v101
    v_cvt_pk_bf16_f32 v149, v102, v103
    v_cvt_pk_bf16_f32 v150, v112, v113
    v_cvt_pk_bf16_f32 v151, v114, v115
    v_pk_max_i16 v148, v148, 0
    v_pk_max_i16 v149, v149, 0
    v_pk_max_i16 v150, v150, 0
    v_pk_max_i16 v151, v151, 0
    s_nop 0
    v_permlane16_swap_b32 v148, v150
    v_permlane16_swap_b32 v149, v151
    s_cmp_eq_u32 s3, 0
    s_cbranch_scc1 Ls41
    buffer_store_dwordx4 v[148:151], v22, s[16:19], s25 offen offset:1024
    s_branch Le42
Ls41:
    buffer_store_dwordx4 v[148:151], v22, s[16:19], s25 offen offset:1024 sc1
Le42:
    s_waitcnt lgkmcnt(0)
    v_fma_f32 v104, -v36, v140, v104
    v_fma_f32 v105, -v36, v141, v105
    v_fma_f32 v106, -v36, v142, v106
    v_fma_f32 v107, -v36, v143, v107
    v_fma_f32 v116, -v38, v140, v116
    v_fma_f32 v117, -v38, v141, v117
    v_fma_f32 v118, -v38, v142, v118
    v_fma_f32 v119, -v38, v143, v119
    v_fma_f32 v104, v37, v104, v80
    v_fma_f32 v105, v37, v105, v81
    v_fma_f32 v106, v37, v106, v82
    v_fma_f32 v107, v37, v107, v83
    v_fma_f32 v116, v39, v116, v80
    v_fma_f32 v117, v39, v117, v81
    v_fma_f32 v118, v39, v118, v82
    v_fma_f32 v119, v39, v119, v83
    v_mul_f32 v104, v104, |v104|
    v_mul_f32 v105, v105, |v105|
    v_mul_f32 v106, v106, |v106|
    v_mul_f32 v107, v107, |v107|
    v_mul_f32 v116, v116, |v116|
    v_mul_f32 v117, v117, |v117|
    v_mul_f32 v118, v118, |v118|
    v_mul_f32 v119, v119, |v119|
    v_cvt_pk_bf16_f32 v152, v104, v105
    v_cvt_pk_bf16_f32 v153, v106, v107
    v_cvt_pk_bf16_f32 v154, v116, v117
    v_cvt_pk_bf16_f32 v155, v118, v119
    v_pk_max_i16 v152, v152, 0
    v_pk_max_i16 v153, v153, 0
    v_pk_max_i16 v154, v154, 0
    v_pk_max_i16 v155, v155, 0
    s_nop 0
    v_permlane16_swap_b32 v152, v154
    v_permlane16_swap_b32 v153, v155
    s_cmp_eq_u32 s3, 0
    s_cbranch_scc1 Ls43
    buffer_store_dwordx4 v[152:155], v22, s[16:19], s25 offen offset:2048
    s_branch Le44
Ls43:
    buffer_store_dwordx4 v[152:155], v22, s[16:19], s25 offen offset:2048 sc1
Le44:
k3_done:
    s_and_b32 s30, s2, 7
    s_lshr_b32 s31, s2, 3
    s_lshl_b32 s21, s30, 2
    s_and_b32 s22, s31, 3
    s_add_u32 s21, s21, s22
    s_lshr_b32 s22, s31, 2
    s_and_b32 s31, s22, 3
    s_cmp_eq_u32 s31, 3
    s_cselect_b32 s31, 4, 0
    s_xor_b32 s22, s22, s31
    s_lshl_b32 s21, s21, 2
    s_lshl_b32 s22, s22, 7
    s_lshr_b32 s23, s20, 1
    s_add_u32 s24, s21, s23
    s_and_b32 s25, s20, 1
    v_lshl_add_u32 v14, v2, 3, v4
    v_lshlrev_b32 v14, 7, v14
    v_lshl_add_u32 v14, v5, 3, v14
    v_and_b32 v15, 1, v2
    v_lshlrev_b32 v15, 1, v15
    v_lshrrev_b32 v13, 1, v4
    v_or_b32 v15, v15, v13
    s_lshl_b32 s26, s25, 1
    v_xor_b32 v15, s26, v15
    v_lshl_add_u32 v14, v15, 5, v14
    s_lshl_b32 s26, s25, 12
    s_add_u32 s26, s26, 0x0
    v_add_u32 v16, s26, v14
    v_xor_b32 v17, 32, v16
    v_xor_b32 v18, 64, v16
    v_xor_b32 v19, 96, v16
    v_mov_b32 v8, v16
    v_mov_b32 v9, v17
    v_mov_b32 v10, v18
    v_mov_b32 v11, v19
    v_add_u32 v16, 0x1c000, v8
    v_add_u32 v17, 0x1c000, v9
    v_add_u32 v18, 0x1c000, v10
    v_add_u32 v19, 0x1c000, v11
    v_add_u32 v12, 0xe000, v8
    v_add_u32 v13, 0xe000, v9
    v_add_u32 v14, 0xe000, v10
    v_add_u32 v15, 0xe000, v11
    ds_read_b64_tr_b16 v[40:41], v8 offset:8192
    ds_read_b64_tr_b16 v[42:43], v8 offset:8704
    ds_read_b64_tr_b16 v[44:45], v9 offset:8192
    ds_read_b64_tr_b16 v[46:47], v9 offset:8704
    ds_read_b64_tr_b16 v[48:49], v10 offset:8192
    ds_read_b64_tr_b16 v[50:51], v10 offset:8704
    ds_read_b64_tr_b16 v[52:53], v11 offset:8192
    ds_read_b64_tr_b16 v[54:55], v11 offset:8704
    ds_read_b64_tr_b16 v[56:57], v8 offset:16384
    ds_read_b64_tr_b16 v[58:59], v8 offset:16896
    ds_read_b64_tr_b16 v[60:61], v9 offset:16384
    ds_read_b64_tr_b16 v[62:63], v9 offset:16896
    ds_read_b64_tr_b16 v[64:65], v10 offset:16384
    ds_read_b64_tr_b16 v[66:67], v10 offset:16896
    ds_read_b64_tr_b16 v[68:69], v11 offset:16384
    ds_read_b64_tr_b16 v[70:71], v11 offset:16896
    v_mov_b32 v21, 1
    v_mov_b32 v22, 0
    s_waitcnt vmcnt(0)
    s_mov_b64 exec, 1
    s_cmp_eq_u32 s3, 0
    s_cbranch_scc1 Ls45
    buffer_store_byte v21, v22, s[16:19], s39 offen
    s_branch Le46
Ls45:
    buffer_store_byte v21, v22, s[16:19], s39 offen sc1
Le46:
    s_mov_b64 exec, -1
    s_lshl_b32 s27, s25, 6
    s_lshr_b32 s26, s22, 0
    s_add_u32 s27, s27, s26
    v_lshlrev_b32 v21, 3, v2
    buffer_load_dwordx2 v[164:165], v21, s[56:59], s27 offen offset:0
    buffer_load_dwordx2 v[166:167], v21, s[56:59], s27 offen offset:32
    s_lshl_b32 s26, s24, 14
    s_add_u32 s26, s26, s27
    v_and_b32 v20, 1, v2
    v_lshlrev_b32 v20, 5, v20
    v_lshrrev_b32 v22, 1, v2
    v_lshl_add_u32 v20, v22, 4, v20
    v_lshl_add_u32 v20, v3, 10, v20
    s_and_b32 s30, s2, 7
    s_lshl_b32 s30, s30, 8
    s_and_b32 s31, s24, 15
    s_lshr_b32 s31, s31, 1
    s_lshl_b32 s31, s31, 5
    s_add_u32 s30, s30, s31
    s_add_u32 s30, s30, 0x981000
    v_lshlrev_b32 v22, 2, v1
    s_lshl_b32 s29, s24, 16
    s_lshl_b32 s31, s25, 10
    s_add_u32 s29, s29, s31
    s_lshl_b32 s32, s20, 11
    s_lshr_b32 s31, s20, 2
    s_cmp_eq_u32 s31, 0
    s_mov_b32 s31, 0xc000
    s_cselect_b32 s31, 0xc000, s31
    s_add_u32 s32, s32, s31
    v_add_u32 v7, s32, v6
    s_waitcnt lgkmcnt(0)
    s_barrier
    s_mov_b64 exec, 0xff
    s_mov_b32 s28, 16384
Lp47:
    buffer_load_dword v23, v22, s[16:19], s30 offen sc1
    s_sub_u32 s28, s28, 1
    s_cbranch_scc1 Lok48
    s_waitcnt vmcnt(0)
    v_cmp_ne_u32 vcc, 0x01010101, v23
    s_cbranch_vccnz Lp47
Lok48:
    s_waitcnt vmcnt(0)
    s_mov_b64 exec, -1
    s_add_u32 s31, s29, 0
    buffer_load_dwordx4 v[88:91], v6, s[16:19], s31 offen offset:0 sc1
    s_add_u32 s31, s29, 0
    buffer_load_dwordx4 v[92:95], v6, s[16:19], s31 offen offset:2048 sc1
    s_add_u32 s31, s29, 4096
    buffer_load_dwordx4 v[96:99], v6, s[16:19], s31 offen offset:0 sc1
    s_add_u32 s31, s29, 4096
    buffer_load_dwordx4 v[100:103], v6, s[16:19], s31 offen offset:2048 sc1
    s_add_u32 s31, s29, 8192
    buffer_load_dwordx4 v[104:107], v6, s[16:19], s31 offen offset:0 sc1
    s_waitcnt vmcnt(4) lgkmcnt(8)
    s_add_u32 s31, s29, 8192
    buffer_load_dwordx4 v[108:111], v6, s[16:19], s31 offen offset:2048 sc1
    ds_read_b64_tr_b16 v[72:73], v8 offset:49152
    ds_read_b64_tr_b16 v[74:75], v8 offset:49664
    ds_read_b64_tr_b16 v[76:77], v9 offset:49152
    ds_read_b64_tr_b16 v[78:79], v9 offset:49664
    ds_read_b64_tr_b16 v[80:81], v10 offset:49152
    ds_read_b64_tr_b16 v[82:83], v10 offset:49664
    ds_read_b64_tr_b16 v[84:85], v11 offset:49152
    ds_read_b64_tr_b16 v[86:87], v11 offset:49664
    v_mfma_f32_16x16x32_bf16 v[32:35], v[48:51], v[88:91], 0
    v_mfma_f32_16x16x32_bf16 v[36:39], v[52:55], v[88:91], 0
    v_mfma_f32_16x16x32_bf16 v[24:27], v[40:43], v[88:91], 0
    v_mfma_f32_16x16x32_bf16 v[28:31], v[44:47], v[88:91], 0
    s_waitcnt vmcnt(4) lgkmcnt(8)
    s_add_u32 s31, s29, 12288
    buffer_load_dwordx4 v[112:115], v6, s[16:19], s31 offen offset:0 sc1
    ds_read_b64_tr_b16 v[40:41], v12 offset:0
    ds_read_b64_tr_b16 v[42:43], v12 offset:512
    ds_read_b64_tr_b16 v[44:45], v13 offset:0
    ds_read_b64_tr_b16 v[46:47], v13 offset:512
    ds_read_b64_tr_b16 v[48:49], v14 offset:0
    ds_read_b64_tr_b16 v[50:51], v14 offset:512
    ds_read_b64_tr_b16 v[52:53], v15 offset:0
    ds_read_b64_tr_b16 v[54:55], v15 offset:512
    v_mfma_f32_16x16x32_bf16 v[32:35], v[64:67], v[92:95], v[32:35]
    v_mfma_f32_16x16x32_bf16 v[36:39], v[68:71], v[92:95], v[36:39]
    v_mfma_f32_16x16x32_bf16 v[24:27], v[56:59], v[92:95], v[24:27]
    v_mfma_f32_16x16x32_bf16 v[28:31], v[60:63], v[92:95], v[28:31]
    s_waitcnt vmcnt(4) lgkmcnt(8)
    s_add_u32 s31, s29, 12288
    buffer_load_dwordx4 v[116:119], v6, s[16:19], s31 offen offset:2048 sc1
    ds_read_b64_tr_b16 v[56:57], v12 offset:8192
    ds_read_b64_tr_b16 v[58:59], v12 offset:8704
    ds_read_b64_tr_b16 v[60:61], v13 offset:8192
    ds_read_b64_tr_b16 v[62:63], v13 offset:8704
    ds_read_b64_tr_b16 v[64:65], v14 offset:8192
    ds_read_b64_tr_b16 v[66:67], v14 offset:8704
    ds_read_b64_tr_b16 v[68:69], v15 offset:8192
    ds_read_b64_tr_b16 v[70:71], v15 offset:8704
    v_mfma_f32_16x16x32_bf16 v[32:35], v[80:83], v[96:99], v[32:35]
    v_mfma_f32_16x16x32_bf16 v[36:39], v[84:87], v[96:99], v[36:39]
    v_mfma_f32_16x16x32_bf16 v[24:27], v[72:75], v[96:99], v[24:27]
    v_mfma_f32_16x16x32_bf16 v[28:31], v[76:79], v[96:99], v[28:31]
    s_waitcnt vmcnt(4) lgkmcnt(8)
    s_add_u32 s31, s29, 16384
    buffer_load_dwordx4 v[120:123], v6, s[16:19], s31 offen offset:0 sc1
    ds_read_b64_tr_b16 v[72:73], v12 offset:16384
    ds_read_b64_tr_b16 v[74:75], v12 offset:16896
    ds_read_b64_tr_b16 v[76:77], v13 offset:16384
    ds_read_b64_tr_b16 v[78:79], v13 offset:16896
    ds_read_b64_tr_b16 v[80:81], v14 offset:16384
    ds_read_b64_tr_b16 v[82:83], v14 offset:16896
    ds_read_b64_tr_b16 v[84:85], v15 offset:16384
    ds_read_b64_tr_b16 v[86:87], v15 offset:16896
    v_mfma_f32_16x16x32_bf16 v[32:35], v[48:51], v[100:103], v[32:35]
    v_mfma_f32_16x16x32_bf16 v[36:39], v[52:55], v[100:103], v[36:39]
    v_mfma_f32_16x16x32_bf16 v[24:27], v[40:43], v[100:103], v[24:27]
    v_mfma_f32_16x16x32_bf16 v[28:31], v[44:47], v[100:103], v[28:31]
    s_waitcnt vmcnt(4) lgkmcnt(8)
    s_add_u32 s31, s29, 16384
    buffer_load_dwordx4 v[124:127], v6, s[16:19], s31 offen offset:2048 sc1
    ds_read_b64_tr_b16 v[40:41], v12 offset:24576
    ds_read_b64_tr_b16 v[42:43], v12 offset:25088
    ds_read_b64_tr_b16 v[44:45], v13 offset:24576
    ds_read_b64_tr_b16 v[46:47], v13 offset:25088
    ds_read_b64_tr_b16 v[48:49], v14 offset:24576
    ds_read_b64_tr_b16 v[50:51], v14 offset:25088
    ds_read_b64_tr_b16 v[52:53], v15 offset:24576
    ds_read_b64_tr_b16 v[54:55], v15 offset:25088
    v_mfma_f32_16x16x32_bf16 v[32:35], v[64:67], v[104:107], v[32:35]
    v_mfma_f32_16x16x32_bf16 v[36:39], v[68:71], v[104:107], v[36:39]
    v_mfma_f32_16x16x32_bf16 v[24:27], v[56:59], v[104:107], v[24:27]
    v_mfma_f32_16x16x32_bf16 v[28:31], v[60:63], v[104:107], v[28:31]
    s_waitcnt vmcnt(4) lgkmcnt(8)
    s_add_u32 s31, s29, 20480
    buffer_load_dwordx4 v[128:131], v6, s[16:19], s31 offen offset:0 sc1
    ds_read_b64_tr_b16 v[56:57], v12 offset:32768
    ds_read_b64_tr_b16 v[58:59], v12 offset:33280
    ds_read_b64_tr_b16 v[60:61], v13 offset:32768
    ds_read_b64_tr_b16 v[62:63], v13 offset:33280
    ds_read_b64_tr_b16 v[64:65], v14 offset:32768
    ds_read_b64_tr_b16 v[66:67], v14 offset:33280
    ds_read_b64_tr_b16 v[68:69], v15 offset:32768
    ds_read_b64_tr_b16 v[70:71], v15 offset:33280
    v_mfma_f32_16x16x32_bf16 v[32:35], v[80:83], v[108:111], v[32:35]
    v_mfma_f32_16x16x32_bf16 v[36:39], v[84:87], v[108:111], v[36:39]
    v_mfma_f32_16x16x32_bf16 v[24:27], v[72:75], v[108:111], v[24:27]
    v_mfma_f32_16x16x32_bf16 v[28:31], v[76:79], v[108:111], v[28:31]
    s_waitcnt vmcnt(4) lgkmcnt(8)
    s_add_u32 s31, s29, 20480
    buffer_load_dwordx4 v[132:135], v6, s[16:19], s31 offen offset:2048 sc1
    ds_read_b64_tr_b16 v[72:73], v8 offset:24576
    ds_read_b64_tr_b16 v[74:75], v8 offset:25088
    ds_read_b64_tr_b16 v[76:77], v9 offset:24576
    ds_read_b64_tr_b16 v[78:79], v9 offset:25088
    ds_read_b64_tr_b16 v[80:81], v10 offset:24576
    ds_read_b64_tr_b16 v[82:83], v10 offset:25088
    ds_read_b64_tr_b16 v[84:85], v11 offset:24576
    ds_read_b64_tr_b16 v[86:87], v11 offset:25088
    v_mfma_f32_16x16x32_bf16 v[32:35], v[48:51], v[112:115], v[32:35]
    v_mfma_f32_16x16x32_bf16 v[36:39], v[52:55], v[112:115], v[36:39]
    v_mfma_f32_16x16x32_bf16 v[24:27], v[40:43], v[112:115], v[24:27]
    v_mfma_f32_16x16x32_bf16 v[28:31], v[44:47], v[112:115], v[28:31]
    s_waitcnt vmcnt(4) lgkmcnt(8)
    s_add_u32 s31, s29, 24576
    buffer_load_dwordx4 v[136:139], v6, s[16:19], s31 offen offset:0 sc1
    ds_read_b64_tr_b16 v[40:41], v12 offset:40960
    ds_read_b64_tr_b16 v[42:43], v12 offset:41472
    ds_read_b64_tr_b16 v[44:45], v13 offset:40960
    ds_read_b64_tr_b16 v[46:47], v13 offset:41472
    ds_read_b64_tr_b16 v[48:49], v14 offset:40960
    ds_read_b64_tr_b16 v[50:51], v14 offset:41472
    ds_read_b64_tr_b16 v[52:53], v15 offset:40960
    ds_read_b64_tr_b16 v[54:55], v15 offset:41472
    v_mfma_f32_16x16x32_bf16 v[32:35], v[64:67], v[116:119], v[32:35]
    v_mfma_f32_16x16x32_bf16 v[36:39], v[68:71], v[116:119], v[36:39]
    v_mfma_f32_16x16x32_bf16 v[24:27], v[56:59], v[116:119], v[24:27]
    v_mfma_f32_16x16x32_bf16 v[28:31], v[60:63], v[116:119], v[28:31]
    s_waitcnt vmcnt(4) lgkmcnt(8)
    s_add_u32 s31, s29, 24576
    buffer_load_dwordx4 v[140:143], v6, s[16:19], s31 offen offset:2048 sc1
    ds_read_b64_tr_b16 v[56:57], v12 offset:49152
    ds_read_b64_tr_b16 v[58:59], v12 offset:49664
    ds_read_b64_tr_b16 v[60:61], v13 offset:49152
    ds_read_b64_tr_b16 v[62:63], v13 offset:49664
    ds_read_b64_tr_b16 v[64:65], v14 offset:49152
    ds_read_b64_tr_b16 v[66:67], v14 offset:49664
    ds_read_b64_tr_b16 v[68:69], v15 offset:49152
    ds_read_b64_tr_b16 v[70:71], v15 offset:49664
    v_mfma_f32_16x16x32_bf16 v[32:35], v[80:83], v[120:123], v[32:35]
    v_mfma_f32_16x16x32_bf16 v[36:39], v[84:87], v[120:123], v[36:39]
    v_mfma_f32_16x16x32_bf16 v[24:27], v[72:75], v[120:123], v[24:27]
    v_mfma_f32_16x16x32_bf16 v[28:31], v[76:79], v[120:123], v[28:31]
    s_waitcnt vmcnt(4) lgkmcnt(8)
    s_add_u32 s31, s29, 28672
    buffer_load_dwordx4 v[144:147], v6, s[16:19], s31 offen offset:0 sc1
    ds_read_b64_tr_b16 v[72:73], v16 offset:24576
    ds_read_b64_tr_b16 v[74:75], v16 offset:25088
    ds_read_b64_tr_b16 v[76:77], v17 offset:24576
    ds_read_b64_tr_b16 v[78:79], v17 offset:25088
    ds_read_b64_tr_b16 v[80:81], v18 offset:24576
    ds_read_b64_tr_b16 v[82:83], v18 offset:25088
    ds_read_b64_tr_b16 v[84:85], v19 offset:24576
    ds_read_b64_tr_b16 v[86:87], v19 offset:25088
    v_mfma_f32_16x16x32_bf16 v[32:35], v[48:51], v[124:127], v[32:35]
    v_mfma_f32_16x16x32_bf16 v[36:39], v[52:55], v[124:127], v[36:39]
    v_mfma_f32_16x16x32_bf16 v[24:27], v[40:43], v[124:127], v[24:27]
    v_mfma_f32_16x16x32_bf16 v[28:31], v[44:47], v[124:127], v[28:31]
    s_waitcnt vmcnt(4) lgkmcnt(8)
    s_add_u32 s31, s29, 28672
    buffer_load_dwordx4 v[148:151], v6, s[16:19], s31 offen offset:2048 sc1
    ds_read_b64_tr_b16 v[40:41], v16 offset:32768
    ds_read_b64_tr_b16 v[42:43], v16 offset:33280
    ds_read_b64_tr_b16 v[44:45], v17 offset:32768
    ds_read_b64_tr_b16 v[46:47], v17 offset:33280
    ds_read_b64_tr_b16 v[48:49], v18 offset:32768
    ds_read_b64_tr_b16 v[50:51], v18 offset:33280
    ds_read_b64_tr_b16 v[52:53], v19 offset:32768
    ds_read_b64_tr_b16 v[54:55], v19 offset:33280
    v_mfma_f32_16x16x32_bf16 v[32:35], v[64:67], v[128:131], v[32:35]
    v_mfma_f32_16x16x32_bf16 v[36:39], v[68:71], v[128:131], v[36:39]
    v_mfma_f32_16x16x32_bf16 v[24:27], v[56:59], v[128:131], v[24:27]
    v_mfma_f32_16x16x32_bf16 v[28:31], v[60:63], v[128:131], v[28:31]
    s_waitcnt lgkmcnt(0)
    s_barrier
    s_waitcnt vmcnt(4) lgkmcnt(8)
    s_add_u32 s31, s29, 32768
    buffer_load_dwordx4 v[152:155], v6, s[16:19], s31 offen offset:0 sc1
    ds_read_b64_tr_b16 v[56:57], v8 offset:0
    ds_read_b64_tr_b16 v[58:59], v8 offset:512
    ds_read_b64_tr_b16 v[60:61], v9 offset:0
    ds_read_b64_tr_b16 v[62:63], v9 offset:512
    ds_read_b64_tr_b16 v[64:65], v10 offset:0
    ds_read_b64_tr_b16 v[66:67], v10 offset:512
    ds_read_b64_tr_b16 v[68:69], v11 offset:0
    ds_read_b64_tr_b16 v[70:71], v11 offset:512
    v_mfma_f32_16x16x32_bf16 v[32:35], v[80:83], v[132:135], v[32:35]
    v_mfma_f32_16x16x32_bf16 v[36:39], v[84:87], v[132:135], v[36:39]
    v_mfma_f32_16x16x32_bf16 v[24:27], v[72:75], v[132:135], v[24:27]
    v_mfma_f32_16x16x32_bf16 v[28:31], v[76:79], v[132:135], v[28:31]
    s_waitcnt vmcnt(4) lgkmcnt(8)
    s_add_u32 s31, s29, 32768
    buffer_load_dwordx4 v[156:159], v6, s[16:19], s31 offen offset:2048 sc1
    ds_read_b64_tr_b16 v[72:73], v8 offset:32768
    ds_read_b64_tr_b16 v[74:75], v8 offset:33280
    ds_read_b64_tr_b16 v[76:77], v9 offset:32768
    ds_read_b64_tr_b16 v[78:79], v9 offset:33280
    ds_read_b64_tr_b16 v[80:81], v10 offset:32768
    ds_read_b64_tr_b16 v[82:83], v10 offset:33280
    ds_read_b64_tr_b16 v[84:85], v11 offset:32768
    ds_read_b64_tr_b16 v[86:87], v11 offset:33280
    v_mfma_f32_16x16x32_bf16 v[32:35], v[48:51], v[136:139], v[32:35]
    v_mfma_f32_16x16x32_bf16 v[36:39], v[52:55], v[136:139], v[36:39]
    v_mfma_f32_16x16x32_bf16 v[24:27], v[40:43], v[136:139], v[24:27]
    v_mfma_f32_16x16x32_bf16 v[28:31], v[44:47], v[136:139], v[28:31]
    s_waitcnt vmcnt(4) lgkmcnt(8)
    s_add_u32 s31, s29, 36864
    buffer_load_dwordx4 v[88:91], v6, s[16:19], s31 offen offset:0 sc1
    ds_read_b64_tr_b16 v[40:41], v8 offset:40960
    ds_read_b64_tr_b16 v[42:43], v8 offset:41472
    ds_read_b64_tr_b16 v[44:45], v9 offset:40960
    ds_read_b64_tr_b16 v[46:47], v9 offset:41472
    ds_read_b64_tr_b16 v[48:49], v10 offset:40960
    ds_read_b64_tr_b16 v[50:51], v10 offset:41472
    ds_read_b64_tr_b16 v[52:53], v11 offset:40960
    ds_read_b64_tr_b16 v[54:55], v11 offset:41472
    v_mfma_f32_16x16x32_bf16 v[32:35], v[64:67], v[140:143], v[32:35]
    v_mfma_f32_16x16x32_bf16 v[36:39], v[68:71], v[140:143], v[36:39]
    v_mfma_f32_16x16x32_bf16 v[24:27], v[56:59], v[140:143], v[24:27]
    v_mfma_f32_16x16x32_bf16 v[28:31], v[60:63], v[140:143], v[28:31]
    s_waitcnt vmcnt(4) lgkmcnt(8)
    s_add_u32 s31, s29, 36864
    buffer_load_dwordx4 v[92:95], v6, s[16:19], s31 offen offset:2048 sc1
    ds_read_b64_tr_b16 v[56:57], v16 offset:0
    ds_read_b64_tr_b16 v[58:59], v16 offset:512
    ds_read_b64_tr_b16 v[60:61], v17 offset:0
    ds_read_b64_tr_b16 v[62:63], v17 offset:512
    ds_read_b64_tr_b16 v[64:65], v18 offset:0
    ds_read_b64_tr_b16 v[66:67], v18 offset:512
    ds_read_b64_tr_b16 v[68:69], v19 offset:0
    ds_read_b64_tr_b16 v[70:71], v19 offset:512
    v_mfma_f32_16x16x32_bf16 v[32:35], v[80:83], v[144:147], v[32:35]
    v_mfma_f32_16x16x32_bf16 v[36:39], v[84:87], v[144:147], v[36:39]
    v_mfma_f32_16x16x32_bf16 v[24:27], v[72:75], v[144:147], v[24:27]
    v_mfma_f32_16x16x32_bf16 v[28:31], v[76:79], v[144:147], v[28:31]
    s_waitcnt vmcnt(4) lgkmcnt(8)
    s_add_u32 s31, s29, 40960
    buffer_load_dwordx4 v[96:99], v6, s[16:19], s31 offen offset:0 sc1
    ds_read_b64_tr_b16 v[72:73], v16 offset:8192
    ds_read_b64_tr_b16 v[74:75], v16 offset:8704
    ds_read_b64_tr_b16 v[76:77], v17 offset:8192
    ds_read_b64_tr_b16 v[78:79], v17 offset:8704
    ds_read_b64_tr_b16 v[80:81], v18 offset:8192
    ds_read_b64_tr_b16 v[82:83], v18 offset:8704
    ds_read_b64_tr_b16 v[84:85], v19 offset:8192
    ds_read_b64_tr_b16 v[86:87], v19 offset:8704
    v_mfma_f32_16x16x32_bf16 v[32:35], v[48:51], v[148:151], v[32:35]
    v_mfma_f32_16x16x32_bf16 v[36:39], v[52:55], v[148:151], v[36:39]
    v_mfma_f32_16x16x32_bf16 v[24:27], v[40:43], v[148:151], v[24:27]
    v_mfma_f32_16x16x32_bf16 v[28:31], v[44:47], v[148:151], v[28:31]
    s_waitcnt vmcnt(4) lgkmcnt(8)
    s_add_u32 s31, s29, 40960
    buffer_load_dwordx4 v[100:103], v6, s[16:19], s31 offen offset:2048 sc1
    ds_read_b64_tr_b16 v[40:41], v16 offset:16384
    ds_read_b64_tr_b16 v[42:43], v16 offset:16896
    ds_read_b64_tr_b16 v[44:45], v17 offset:16384
    ds_read_b64_tr_b16 v[46:47], v17 offset:16896
    ds_read_b64_tr_b16 v[48:49], v18 offset:16384
    ds_read_b64_tr_b16 v[50:51], v18 offset:16896
    ds_read_b64_tr_b16 v[52:53], v19 offset:16384
    ds_read_b64_tr_b16 v[54:55], v19 offset:16896
    v_mfma_f32_16x16x32_bf16 v[32:35], v[64:67], v[152:155], v[32:35]
    v_mfma_f32_16x16x32_bf16 v[36:39], v[68:71], v[152:155], v[36:39]
    v_mfma_f32_16x16x32_bf16 v[24:27], v[56:59], v[152:155], v[24:27]
    v_mfma_f32_16x16x32_bf16 v[28:31], v[60:63], v[152:155], v[28:31]
    s_waitcnt vmcnt(4) lgkmcnt(8)
    ds_read_b64_tr_b16 v[56:57], v16 offset:40960
    ds_read_b64_tr_b16 v[58:59], v16 offset:41472
    ds_read_b64_tr_b16 v[60:61], v17 offset:40960
    ds_read_b64_tr_b16 v[62:63], v17 offset:41472
    ds_read_b64_tr_b16 v[64:65], v18 offset:40960
    ds_read_b64_tr_b16 v[66:67], v18 offset:41472
    ds_read_b64_tr_b16 v[68:69], v19 offset:40960
    ds_read_b64_tr_b16 v[70:71], v19 offset:41472
    v_mfma_f32_16x16x32_bf16 v[32:35], v[80:83], v[156:159], v[32:35]
    v_mfma_f32_16x16x32_bf16 v[36:39], v[84:87], v[156:159], v[36:39]
    v_mfma_f32_16x16x32_bf16 v[24:27], v[72:75], v[156:159], v[24:27]
    v_mfma_f32_16x16x32_bf16 v[28:31], v[76:79], v[156:159], v[28:31]
    s_waitcnt vmcnt(3) lgkmcnt(8)
    ds_read_b64_tr_b16 v[72:73], v8 offset:8192
    ds_read_b64_tr_b16 v[74:75], v8 offset:8704
    ds_read_b64_tr_b16 v[76:77], v9 offset:8192
    ds_read_b64_tr_b16 v[78:79], v9 offset:8704
    ds_read_b64_tr_b16 v[80:81], v10 offset:8192
    ds_read_b64_tr_b16 v[82:83], v10 offset:8704
    ds_read_b64_tr_b16 v[84:85], v11 offset:8192
    ds_read_b64_tr_b16 v[86:87], v11 offset:8704
    v_mfma_f32_16x16x32_bf16 v[32:35], v[48:51], v[88:91], v[32:35]
    v_mfma_f32_16x16x32_bf16 v[36:39], v[52:55], v[88:91], v[36:39]
    v_mfma_f32_16x16x32_bf16 v[24:27], v[40:43], v[88:91], v[24:27]
    v_mfma_f32_16x16x32_bf16 v[28:31], v[44:47], v[88:91], v[28:31]
    s_waitcnt vmcnt(2) lgkmcnt(8)
    ds_read_b64_tr_b16 v[40:41], v8 offset:16384
    ds_read_b64_tr_b16 v[42:43], v8 offset:16896
    ds_read_b64_tr_b16 v[44:45], v9 offset:16384
    ds_read_b64_tr_b16 v[46:47], v9 offset:16896
    ds_read_b64_tr_b16 v[48:49], v10 offset:16384
    ds_read_b64_tr_b16 v[50:51], v10 offset:16896
    ds_read_b64_tr_b16 v[52:53], v11 offset:16384
    ds_read_b64_tr_b16 v[54:55], v11 offset:16896
    v_mfma_f32_16x16x32_bf16 v[32:35], v[64:67], v[92:95], v[32:35]
    v_mfma_f32_16x16x32_bf16 v[36:39], v[68:71], v[92:95], v[36:39]
    v_mfma_f32_16x16x32_bf16 v[24:27], v[56:59], v[92:95], v[24:27]
    v_mfma_f32_16x16x32_bf16 v[28:31], v[60:63], v[92:95], v[28:31]
    s_waitcnt vmcnt(1) lgkmcnt(8)
    v_mfma_f32_16x16x32_bf16 v[32:35], v[80:83], v[96:99], v[32:35]
    v_mfma_f32_16x16x32_bf16 v[36:39], v[84:87], v[96:99], v[36:39]
    v_mfma_f32_16x16x32_bf16 v[24:27], v[72:75], v[96:99], v[24:27]
    v_mfma_f32_16x16x32_bf16 v[28:31], v[76:79], v[96:99], v[28:31]
    s_waitcnt vmcnt(0) lgkmcnt(0)
    s_cmp_eq_u32 s25, 1
    s_cbranch_scc1 k4_skip
    v_mfma_f32_16x16x32_bf16 v[32:35], v[48:51], v[100:103], v[32:35]
    v_mfma_f32_16x16x32_bf16 v[36:39], v[52:55], v[100:103], v[36:39]
    v_mfma_f32_16x16x32_bf16 v[24:27], v[40:43], v[100:103], v[24:27]
    v_mfma_f32_16x16x32_bf16 v[28:31], v[44:47], v[100:103], v[28:31]
k4_skip:
    s_nop 7
    ds_write_b128 v7, v[32:35] offset:0
    ds_write_b128 v7, v[36:39] offset:1024
    v_xor_b32 v7, 0x800, v7
    v_lshlrev_b32 v96, 16, v160
    v_and_b32 v97, 0xffff0000, v160
    v_lshlrev_b32 v104, 16, v164
    v_and_b32 v164, 0xffff0000, v164
    v_lshlrev_b32 v98, 16, v161
    v_and_b32 v99, 0xffff0000, v161
    v_lshlrev_b32 v105, 16, v165
    v_and_b32 v165, 0xffff0000, v165
    v_lshlrev_b32 v100, 16, v162
    v_and_b32 v101, 0xffff0000, v162
    v_lshlrev_b32 v106, 16, v166
    v_and_b32 v166, 0xffff0000, v166
    v_lshlrev_b32 v102, 16, v163
    v_and_b32 v103, 0xffff0000, v163
    v_lshlrev_b32 v107, 16, v167
    v_and_b32 v167, 0xffff0000, v167
    v_add_f32 v96, v96, v104
    v_add_f32 v97, v97, v164
    v_add_f32 v98, v98, v105
    v_add_f32 v99, v99, v165
    v_add_f32 v100, v100, v106
    v_add_f32 v101, v101, v166
    v_add_f32 v102, v102, v107
    v_add_f32 v103, v103, v167
    s_waitcnt lgkmcnt(0)
    s_barrier
    ds_read_b128 v[112:115], v7 offset:0
    ds_read_b128 v[116:119], v7 offset:1024
    s_waitcnt lgkmcnt(1)
    v_add_f32 v24, v24, v112
    v_add_f32 v25, v25, v113
    v_add_f32 v26, v26, v114
    v_add_f32 v27, v27, v115
    s_waitcnt lgkmcnt(0)
    v_add_f32 v28, v28, v116
    v_add_f32 v29, v29, v117
    v_add_f32 v30, v30, v118
    v_add_f32 v31, v31, v119
    v_add_f32 v96, v96, v24
    v_add_f32 v97, v97, v25
    v_add_f32 v98, v98, v26
    v_add_f32 v99, v99, v27
    v_add_f32 v100, v100, v28
    v_add_f32 v101, v101, v29
    v_add_f32 v102, v102, v30
    v_add_f32 v103, v103, v31
    v_cvt_pk_bf16_f32 v56, v96, v97
    v_cvt_pk_bf16_f32 v57, v98, v99
    v_cvt_pk_bf16_f32 v58, v100, v101
    v_cvt_pk_bf16_f32 v59, v102, v103
    s_nop 0
    v_permlane16_swap_b32 v56, v58
    v_permlane16_swap_b32 v57, v59
    buffer_store_dwordx4 v[56:59], v20, s[60:63], s26 offen
mega_exit:
    s_endpgm
prod_w:
    s_sub_u32 s35, s20, 8
    s_lshl_b32 s32, s35, 10
    s_mul_i32 s31, s35, 49152
    s_add_u32 s31, s31, s22
    v_lshrrev_b32 v7, 2, v1
    v_mul_u32_u24 v7, 0xc00, v7
    v_bfe_u32 v15, v1, 5, 1
    v_lshlrev_b32 v15, 1, v15
    v_xor_b32 v15, v15, v5
    v_lshl_add_u32 v7, v15, 4, v7
    v_add_u32 v7, s31, v7
    s_add_u32 s29, s39, 0
    s_and_b32 s29, s29, 15
    s_mul_i32 s29, s29, 98304
    s_add_u32 m0, s32, 0x0
    s_add_u32 s30, s29, 0x0
    buffer_load_dwordx4 v7, s[8:11], s30 offen lds
    s_add_u32 m0, s32, 0x800
    s_add_u32 s30, s29, 0x400
    buffer_load_dwordx4 v7, s[8:11], s30 offen lds
    s_add_u32 m0, s32, 0x1000
    s_add_u32 s30, s29, 0x800
    buffer_load_dwordx4 v7, s[8:11], s30 offen lds
    s_add_u32 s29, s39, 1
    s_and_b32 s29, s29, 15
    s_mul_i32 s29, s29, 98304
    s_add_u32 m0, s32, 0x3800
    s_add_u32 s30, s29, 0x0
    buffer_load_dwordx4 v7, s[8:11], s30 offen lds
    s_add_u32 m0, s32, 0x4000
    s_add_u32 s30, s29, 0x400
    buffer_load_dwordx4 v7, s[8:11], s30 offen lds
    s_add_u32 m0, s32, 0x4800
    s_add_u32 s30, s29, 0x800
    buffer_load_dwordx4 v7, s[8:11], s30 offen lds
    s_add_u32 s29, s39, 2
    s_and_b32 s29, s29, 15
    s_mul_i32 s29, s29, 98304
    s_add_u32 m0, s32, 0x7000
    s_add_u32 s30, s29, 0x0
    buffer_load_dwordx4 v7, s[8:11], s30 offen lds
    s_add_u32 m0, s32, 0x7800
    s_add_u32 s30, s29, 0x400
    buffer_load_dwordx4 v7, s[8:11], s30 offen lds
    s_add_u32 m0, s32, 0x8000
    s_add_u32 s30, s29, 0x800
    buffer_load_dwordx4 v7, s[8:11], s30 offen lds
    s_mov_b32 m0, 0x27000
    s_lshl_b32 s30, s34, 10
    buffer_load_dwordx4 v6, s[12:15], s30 offen lds
    s_add_u32 s29, s39, 3
    s_and_b32 s29, s29, 15
    s_mul_i32 s29, s29, 98304
    s_add_u32 m0, s32, 0xa800
    s_add_u32 s30, s29, 0x0
    buffer_load_dwordx4 v7, s[8:11], s30 offen lds
    s_add_u32 m0, s32, 0xb000
    s_add_u32 s30, s29, 0x400
    buffer_load_dwordx4 v7, s[8:11], s30 offen lds
    s_add_u32 m0, s32, 0xb800
    s_add_u32 s30, s29, 0x800
    buffer_load_dwordx4 v7, s[8:11], s30 offen lds
    s_add_u32 s29, s39, 4
    s_and_b32 s29, s29, 15
    s_mul_i32 s29, s29, 98304
    s_add_u32 m0, s32, 0xe000
    s_add_u32 s30, s29, 0x0
    buffer_load_dwordx4 v7, s[8:11], s30 offen lds
    s_add_u32 m0, s32, 0xe800
    s_add_u32 s30, s29, 0x400
    buffer_load_dwordx4 v7, s[8:11], s30 offen lds
    s_add_u32 m0, s32, 0xf000
    s_add_u32 s30, s29, 0x800
    buffer_load_dwordx4 v7, s[8:11], s30 offen lds
    s_waitcnt vmcnt(13)
    s_barrier
    s_add_u32 s29, s39, 5
    s_and_b32 s29, s29, 15
    s_mul_i32 s29, s29, 98304
    s_add_u32 m0, s32, 0x11800
    s_add_u32 s30, s29, 0x0
    buffer_load_dwordx4 v7, s[8:11], s30 offen lds
    s_add_u32 m0, s32, 0x12000
    s_add_u32 s30, s29, 0x400
    buffer_load_dwordx4 v7, s[8:11], s30 offen lds
    s_add_u32 m0, s32, 0x12800
    s_add_u32 s30, s29, 0x800
    buffer_load_dwordx4 v7, s[8:11], s30 offen lds
    s_and_b32 s41, s41, 0xffff
    s_mov_b32 s42, 0x80000
    s_mov_b32 s43, 0x00020000
    s_and_b32 s45, s45, 0xffff
    s_mov_b32 s46, 0x158000
    s_mov_b32 s47, 0x00020000
    s_and_b32 s49, s49, 0xffff
    s_mov_b32 s50, 0x158000
    s_mov_b32 s51, 0x00020000
    s_and_b32 s53, s53, 0xffff
    s_mov_b32 s54, 0xac0
    s_mov_b32 s55, 0x00020000
    s_and_b32 s57, s57, 0xffff
    s_mov_b32 s58, 0x400
    s_mov_b32 s59, 0x00020000
    s_and_b32 s61, s61, 0xffff
    s_mov_b32 s62, 0x200000
    s_mov_b32 s63, 0x00020000
    s_and_b32 s65, s65, 0xffff
    s_mov_b32 s66, 0x100
    s_mov_b32 s67, 0x00020000
    s_lshr_b32 s24, s2, 3
    s_mul_i32 s24, s24, 44032
    s_lshl_b32 s27, s35, 7
    s_add_u32 s24, s24, s27
    s_buffer_load_dwordx2 s[100:101], s[48:51], s24 offset:0x3c
    s_buffer_load_dwordx2 s[100:101], s[48:51], s24 offset:0x13c
    s_buffer_load_dwordx2 s[100:101], s[48:51], s24 offset:0x23c
    s_buffer_load_dwordx2 s[100:101], s[48:51], s24 offset:0x33c
    s_buffer_load_dwordx2 s[100:101], s[48:51], s24 offset:0x43c
    s_buffer_load_dwordx2 s[100:101], s[48:51], s24 offset:0x53c
    s_buffer_load_dwordx2 s[100:101], s[48:51], s24 offset:0x63c
    s_waitcnt vmcnt(13)
    s_barrier
    s_add_u32 s29, s39, 6
    s_and_b32 s29, s29, 15
    s_mul_i32 s29, s29, 98304
    s_add_u32 m0, s32, 0x15000
    s_add_u32 s30, s29, 0x0
    buffer_load_dwordx4 v7, s[8:11], s30 offen lds
    s_add_u32 m0, s32, 0x15800
    s_add_u32 s30, s29, 0x400
    buffer_load_dwordx4 v7, s[8:11], s30 offen lds
    s_add_u32 m0, s32, 0x16000
    s_add_u32 s30, s29, 0x800
    buffer_load_dwordx4 v7, s[8:11], s30 offen lds
    s_waitcnt vmcnt(9)
    s_barrier
    s_add_u32 s29, s39, 7
    s_and_b32 s29, s29, 15
    s_mul_i32 s29, s29, 98304
    s_add_u32 m0, s32, 0x18800
    s_add_u32 s30, s29, 0x0
    buffer_load_dwordx4 v7, s[8:11], s30 offen lds
    s_add_u32 m0, s32, 0x19000
    s_add_u32 s30, s29, 0x400
    buffer_load_dwordx4 v7, s[8:11], s30 offen lds
    s_add_u32 m0, s32, 0x19800
    s_add_u32 s30, s29, 0x800
    buffer_load_dwordx4 v7, s[8:11], s30 offen lds
    s_add_u32 s29, s39, 8
    s_and_b32 s29, s29, 15
    s_mul_i32 s29, s29, 98304
    s_add_u32 m0, s32, 0x1c000
    s_add_u32 s30, s29, 0x0
    buffer_load_dwordx4 v7, s[8:11], s30 offen lds
    s_add_u32 m0, s32, 0x1c800
    s_add_u32 s30, s29, 0x400
    buffer_load_dwordx4 v7, s[8:11], s30 offen lds
    s_add_u32 m0, s32, 0x1d000
    s_add_u32 s30, s29, 0x800
    buffer_load_dwordx4 v7, s[8:11], s30 offen lds
    s_lshr_b32 s24, s2, 3
    s_mul_i32 s24, s24, 44032
    s_lshl_b32 s27, s35, 7
    s_add_u32 s24, s24, s27
    s_buffer_load_dwordx2 s[100:101], s[48:51], s24 offset:0xe3c
    s_buffer_load_dwordx2 s[100:101], s[48:51], s24 offset:0xf3c
    s_buffer_load_dwordx2 s[100:101], s[48:51], s24 offset:0x103c
    s_buffer_load_dwordx2 s[100:101], s[48:51], s24 offset:0x113c
    s_buffer_load_dwordx2 s[100:101], s[48:51], s24 offset:0x123c
    s_buffer_load_dwordx2 s[100:101], s[48:51], s24 offset:0x133c
    s_buffer_load_dwordx2 s[100:101], s[48:51], s24 offset:0x143c
    s_waitcnt vmcnt(9)
    s_barrier
    s_add_u32 s29, s39, 9
    s_and_b32 s29, s29, 15
    s_mul_i32 s29, s29, 98304
    s_add_u32 m0, s32, 0x1f800
    s_add_u32 s30, s29, 0x0
    buffer_load_dwordx4 v7, s[8:11], s30 offen lds
    s_add_u32 m0, s32, 0x20000
    s_add_u32 s30, s29, 0x400
    buffer_load_dwordx4 v7, s[8:11], s30 offen lds
    s_add_u32 m0, s32, 0x20800
    s_add_u32 s30, s29, 0x800
    buffer_load_dwordx4 v7, s[8:11], s30 offen lds
    s_add_u32 s29, s39, 10
    s_and_b32 s29, s29, 15
    s_mul_i32 s29, s29, 98304
    s_add_u32 m0, s32, 0x23000
    s_add_u32 s30, s29, 0x0
    buffer_load_dwordx4 v7, s[8:11], s30 offen lds
    s_add_u32 m0, s32, 0x23800
    s_add_u32 s30, s29, 0x400
    buffer_load_dwordx4 v7, s[8:11], s30 offen lds
    s_add_u32 m0, s32, 0x24000
    s_add_u32 s30, s29, 0x800
    buffer_load_dwordx4 v7, s[8:11], s30 offen lds
    s_waitcnt vmcnt(9)
    s_barrier
    s_add_u32 s29, s39, 11
    s_and_b32 s29, s29, 15
    s_mul_i32 s29, s29, 98304
    s_add_u32 m0, s32, 0x0
    s_add_u32 s30, s29, 0x0
    buffer_load_dwordx4 v7, s[8:11], s30 offen lds
    s_add_u32 m0, s32, 0x800
    s_add_u32 s30, s29, 0x400
    buffer_load_dwordx4 v7, s[8:11], s30 offen lds
    s_add_u32 m0, s32, 0x1000
    s_add_u32 s30, s29, 0x800
    buffer_load_dwordx4 v7, s[8:11], s30 offen lds
    s_add_u32 s29, s39, 12
    s_and_b32 s29, s29, 15
    s_mul_i32 s29, s29, 98304
    s_add_u32 m0, s32, 0x3800
    s_add_u32 s30, s29, 0x0
    buffer_load_dwordx4 v7, s[8:11], s30 offen lds
    s_add_u32 m0, s32, 0x4000
    s_add_u32 s30, s29, 0x400
    buffer_load_dwordx4 v7, s[8:11], s30 offen lds
    s_add_u32 m0, s32, 0x4800
    s_add_u32 s30, s29, 0x800
    buffer_load_dwordx4 v7, s[8:11], s30 offen lds
    s_lshr_b32 s24, s2, 3
    s_mul_i32 s24, s24, 44032
    s_lshl_b32 s27, s35, 7
    s_add_u32 s24, s24, s27
    s_buffer_load_dwordx2 s[100:101], s[48:51], s24 offset:0x1c3c
    s_buffer_load_dwordx2 s[100:101], s[48:51], s24 offset:0x1d3c
    s_buffer_load_dwordx2 s[100:101], s[48:51], s24 offset:0x1e3c
    s_buffer_load_dwordx2 s[100:101], s[48:51], s24 offset:0x1f3c
    s_buffer_load_dwordx2 s[100:101], s[48:51], s24 offset:0x203c
    s_buffer_load_dwordx2 s[100:101], s[48:51], s24 offset:0x213c
    s_buffer_load_dwordx2 s[100:101], s[48:51], s24 offset:0x223c
    s_waitcnt vmcnt(9)
    s_barrier
    s_add_u32 s29, s39, 13
    s_and_b32 s29, s29, 15
    s_mul_i32 s29, s29, 98304
    s_add_u32 m0, s32, 0x7000
    s_add_u32 s30, s29, 0x0
    buffer_load_dwordx4 v7, s[8:11], s30 offen lds
    s_add_u32 m0, s32, 0x7800
    s_add_u32 s30, s29, 0x400
    buffer_load_dwordx4 v7, s[8:11], s30 offen lds
    s_add_u32 m0, s32, 0x8000
    s_add_u32 s30, s29, 0x800
    buffer_load_dwordx4 v7, s[8:11], s30 offen lds
    s_add_u32 s29, s39, 14
    s_and_b32 s29, s29, 15
    s_mul_i32 s29, s29, 98304
    s_add_u32 m0, s32, 0xa800
    s_add_u32 s30, s29, 0x0
    buffer_load_dwordx4 v7, s[8:11], s30 offen lds
    s_add_u32 m0, s32, 0xb000
    s_add_u32 s30, s29, 0x400
    buffer_load_dwordx4 v7, s[8:11], s30 offen lds
    s_add_u32 m0, s32, 0xb800
    s_add_u32 s30, s29, 0x800
    buffer_load_dwordx4 v7, s[8:11], s30 offen lds
    s_waitcnt vmcnt(9)
    s_barrier
    s_add_u32 s29, s39, 15
    s_and_b32 s29, s29, 15
    s_mul_i32 s29, s29, 98304
    s_add_u32 m0, s32, 0xe000
    s_add_u32 s30, s29, 0x0
    buffer_load_dwordx4 v7, s[8:11], s30 offen lds
    s_add_u32 m0, s32, 0xe800
    s_add_u32 s30, s29, 0x400
    buffer_load_dwordx4 v7, s[8:11], s30 offen lds
    s_add_u32 m0, s32, 0xf000
    s_add_u32 s30, s29, 0x800
    buffer_load_dwordx4 v7, s[8:11], s30 offen lds
    s_lshr_b32 s24, s2, 3
    s_mul_i32 s24, s24, 44032
    s_lshl_b32 s27, s35, 7
    s_add_u32 s24, s24, s27
    s_buffer_load_dwordx2 s[100:101], s[48:51], s24 offset:0x2a3c
    s_buffer_load_dwordx2 s[100:101], s[48:51], s24 offset:0x2b3c
    s_buffer_load_dwordx2 s[100:101], s[48:51], s24 offset:0x2c3c
    s_buffer_load_dwordx2 s[100:101], s[48:51], s24 offset:0x2d3c
    s_buffer_load_dwordx2 s[100:101], s[48:51], s24 offset:0x2e3c
    s_buffer_load_dwordx2 s[100:101], s[48:51], s24 offset:0x2f3c
    s_buffer_load_dwordx2 s[100:101], s[48:51], s24 offset:0x303c
    s_waitcnt vmcnt(6)
    s_barrier
    s_waitcnt vmcnt(0)
    s_barrier
    s_lshr_b32 s24, s2, 3
    s_mul_i32 s24, s24, 44032
    s_lshl_b32 s27, s35, 7
    s_add_u32 s24, s24, s27
    s_buffer_load_dwordx2 s[100:101], s[48:51], s24 offset:0x383c
    s_buffer_load_dwordx2 s[100:101], s[48:51], s24 offset:0x393c
    s_buffer_load_dwordx2 s[100:101], s[48:51], s24 offset:0x3a3c
    s_buffer_load_dwordx2 s[100:101], s[48:51], s24 offset:0x3b3c
    s_buffer_load_dwordx2 s[100:101], s[48:51], s24 offset:0x3c3c
    s_buffer_load_dwordx2 s[100:101], s[48:51], s24 offset:0x3d3c
    s_buffer_load_dwordx2 s[100:101], s[48:51], s24 offset:0x3e3c
    s_and_b32 s30, s2, 7
    s_lshr_b32 s31, s2, 3
    s_lshl_b32 s21, s30, 2
    s_and_b32 s22, s31, 3
    s_add_u32 s21, s21, s22
    s_lshr_b32 s22, s31, 2
    s_and_b32 s31, s22, 3
    s_cmp_eq_u32 s31, 3
    s_cselect_b32 s31, 4, 0
    s_xor_b32 s22, s22, s31
    s_lshl_b32 s21, s21, 2
    s_lshl_b32 s22, s22, 7
    s_lshl_b32 s31, s35, 13
    s_lshr_b32 s30, s22, 0
    s_add_u32 s31, s31, s30
    v_lshrrev_b32 v8, 3, v1
    v_bfe_u32 v9, v1, 1, 2
    v_and_b32 v10, 1, v1
    v_lshlrev_b32 v10, 4, v10
    v_lshl_add_u32 v8, v8, 10, v10
    v_add_u32 v8, s31, v8
    v_bfe_u32 v10, v1, 4, 1
    v_xor_b32 v10, v9, v10
    s_lshl_b32 s30, s35, 1
    v_xor_b32 v10, s30, v10
    v_lshl_add_u32 v12, v10, 5, v8
    v_bfe_u32 v10, v1, 4, 2
    v_xor_b32 v10, v9, v10
    v_lshl_add_u32 v11, v10, 5, v8
    v_lshl_add_u32 v13, v9, 5, v8
    s_lshl_b32 s36, s21, 14
    s_and_b32 s30, s2, 7
    s_lshr_b32 s31, s2, 3
    s_lshl_b32 s21, s30, 1
    s_and_b32 s22, s31, 1
    s_add_u32 s33, s21, s22
    s_lshr_b32 s34, s31, 1
    s_lshl_b32 s21, s33, 7
    s_min_u32 s22, s34, 14
    s_mul_i32 s22, s22, 192
    s_mul_i32 s31, s35, 44032
    s_add_u32 s31, s31, s22
    v_lshrrev_b32 v7, 2, v1
    v_mul_u32_u24 v7, 0xac0, v7
    v_bfe_u32 v15, v1, 4, 1
    v_lshlrev_b32 v15, 1, v15
    v_xor_b32 v15, v15, v5
    v_lshl_add_u32 v7, v15, 4, v7
    v_add_u32 v7, s31, v7
    s_barrier
    s_add_u32 m0, s32, 0x12000
    s_mov_b32 s30, 0x0
    buffer_load_dwordx4 v11, s[40:43], s30 offen lds
    s_add_u32 m0, s32, 0x12800
    s_mov_b32 s30, 0x4000
    buffer_load_dwordx4 v11, s[40:43], s30 offen lds
    s_add_u32 m0, s32, 0x13000
    s_mov_b32 s30, 0x8000
    buffer_load_dwordx4 v11, s[40:43], s30 offen lds
    s_add_u32 m0, s32, 0x13800
    s_mov_b32 s30, 0xc000
    buffer_load_dwordx4 v11, s[40:43], s30 offen lds
    s_add_u32 m0, s32, 0x14000
    s_mov_b32 s30, 0x10000
    buffer_load_dwordx4 v11, s[40:43], s30 offen lds
    s_add_u32 m0, s32, 0x14800
    s_mov_b32 s30, 0x14000
    buffer_load_dwordx4 v11, s[40:43], s30 offen lds
    s_add_u32 m0, s32, 0x15000
    s_mov_b32 s30, 0x18000
    buffer_load_dwordx4 v11, s[40:43], s30 offen lds
    s_add_u32 m0, s32, 0x15800
    s_mov_b32 s30, 0x1c000
    buffer_load_dwordx4 v11, s[40:43], s30 offen lds
    s_add_u32 m0, s32, 0x16000
    s_mov_b32 s30, 0x20000
    buffer_load_dwordx4 v11, s[40:43], s30 offen lds
    s_add_u32 m0, s32, 0x16800
    s_mov_b32 s30, 0x24000
    buffer_load_dwordx4 v11, s[40:43], s30 offen lds
    s_add_u32 m0, s32, 0x17000
    s_mov_b32 s30, 0x28000
    buffer_load_dwordx4 v11, s[40:43], s30 offen lds
    s_add_u32 m0, s32, 0x17800
    s_mov_b32 s30, 0x2c000
    buffer_load_dwordx4 v11, s[40:43], s30 offen lds
    s_add_u32 m0, s32, 0x18000
    s_mov_b32 s30, 0x30000
    buffer_load_dwordx4 v11, s[40:43], s30 offen lds
    s_add_u32 m0, s32, 0x18800
    s_mov_b32 s30, 0x34000
    buffer_load_dwordx4 v11, s[40:43], s30 offen lds
    s_add_u32 m0, s32, 0x19000
    s_mov_b32 s30, 0x38000
    buffer_load_dwordx4 v11, s[40:43], s30 offen lds
    s_add_u32 m0, s32, 0x19800
    s_mov_b32 s30, 0x3c000
    buffer_load_dwordx4 v11, s[40:43], s30 offen lds
    s_add_u32 m0, s32, 0x1a000
    s_mov_b32 s30, 0x40000
    buffer_load_dwordx4 v11, s[40:43], s30 offen lds
    s_add_u32 m0, s32, 0x1a800
    s_mov_b32 s30, 0x44000
    buffer_load_dwordx4 v11, s[40:43], s30 offen lds
    s_add_u32 m0, s32, 0x1b000
    s_mov_b32 s30, 0x48000
    buffer_load_dwordx4 v11, s[40:43], s30 offen lds
    s_add_u32 m0, s32, 0x1b800
    s_mov_b32 s30, 0x4c000
    buffer_load_dwordx4 v11, s[40:43], s30 offen lds
    s_add_u32 m0, s32, 0x1c000
    s_mov_b32 s30, 0x50000
    buffer_load_dwordx4 v11, s[40:43], s30 offen lds
    s_add_u32 m0, s32, 0x1c800
    s_mov_b32 s30, 0x54000
    buffer_load_dwordx4 v11, s[40:43], s30 offen lds
    s_add_u32 m0, s32, 0x1d000
    s_mov_b32 s30, 0x58000
    buffer_load_dwordx4 v11, s[40:43], s30 offen lds
    s_add_u32 m0, s32, 0x1d800
    s_mov_b32 s30, 0x5c000
    buffer_load_dwordx4 v11, s[40:43], s30 offen lds
    s_add_u32 m0, s32, 0x1e000
    s_mov_b32 s30, 0x60000
    buffer_load_dwordx4 v11, s[40:43], s30 offen lds
    s_add_u32 m0, s32, 0x1e800
    s_mov_b32 s30, 0x64000
    buffer_load_dwordx4 v11, s[40:43], s30 offen lds
    s_add_u32 m0, s32, 0x1f000
    s_mov_b32 s30, 0x68000
    buffer_load_dwordx4 v11, s[40:43], s30 offen lds
    s_add_u32 m0, s32, 0x1f800
    s_mov_b32 s30, 0x6c000
    buffer_load_dwordx4 v11, s[40:43], s30 offen lds
    s_add_u32 m0, s32, 0x20000
    s_mov_b32 s30, 0x70000
    buffer_load_dwordx4 v11, s[40:43], s30 offen lds
    s_add_u32 m0, s32, 0x20800
    s_mov_b32 s30, 0x74000
    buffer_load_dwordx4 v11, s[40:43], s30 offen lds
    s_add_u32 m0, s32, 0x21000
    s_mov_b32 s30, 0x78000
    buffer_load_dwordx4 v11, s[40:43], s30 offen lds
    s_add_u32 m0, s32, 0x21800
    s_mov_b32 s30, 0x7c000
    buffer_load_dwordx4 v11, s[40:43], s30 offen lds
    s_add_u32 m0, s32, 0x22000
    s_add_u32 s30, s36, 0x0
    buffer_load_dwordx4 v13, s[4:7], s30 offen lds
    s_add_u32 m0, s32, 0x22800
    s_add_u32 s30, s36, 0x4000
    buffer_load_dwordx4 v13, s[4:7], s30 offen lds
    s_add_u32 m0, s32, 0x23000
    s_add_u32 s30, s36, 0x8000
    buffer_load_dwordx4 v13, s[4:7], s30 offen lds
    s_add_u32 m0, s32, 0x23800
    s_add_u32 s30, s36, 0xc000
    buffer_load_dwordx4 v13, s[4:7], s30 offen lds
    s_lshr_b32 s24, s2, 3
    s_mul_i32 s24, s24, 44032
    s_lshl_b32 s27, s35, 7
    s_add_u32 s24, s24, s27
    s_buffer_load_dwordx2 s[100:101], s[48:51], s24 offset:0x463c
    s_buffer_load_dwordx2 s[100:101], s[48:51], s24 offset:0x473c
    s_buffer_load_dwordx2 s[100:101], s[48:51], s24 offset:0x483c
    s_buffer_load_dwordx2 s[100:101], s[48:51], s24 offset:0x493c
    s_buffer_load_dwordx2 s[100:101], s[48:51], s24 offset:0x4a3c
    s_buffer_load_dwordx2 s[100:101], s[48:51], s24 offset:0x4b3c
    s_buffer_load_dwordx2 s[100:101], s[48:51], s24 offset:0x4c3c
    s_waitcnt lgkmcnt(0)
    s_lshr_b32 s24, s2, 3
    s_mul_i32 s24, s24, 44032
    s_lshl_b32 s27, s35, 7
    s_add_u32 s24, s24, s27
    s_buffer_load_dwordx2 s[100:101], s[48:51], s24 offset:0x543c
    s_buffer_load_dwordx2 s[100:101], s[48:51], s24 offset:0x553c
    s_buffer_load_dwordx2 s[100:101], s[48:51], s24 offset:0x563c
    s_buffer_load_dwordx2 s[100:101], s[48:51], s24 offset:0x573c
    s_buffer_load_dwordx2 s[100:101], s[48:51], s24 offset:0x583c
    s_buffer_load_dwordx2 s[100:101], s[48:51], s24 offset:0x593c
    s_buffer_load_dwordx2 s[100:101], s[48:51], s24 offset:0x5a3c
    s_barrier
    s_lshr_b32 s24, s2, 3
    s_mul_i32 s24, s24, 44032
    s_lshl_b32 s27, s35, 7
    s_add_u32 s24, s24, s27
    s_buffer_load_dwordx2 s[100:101], s[48:51], s24 offset:0x5b3c
    s_buffer_load_dwordx2 s[100:101], s[48:51], s24 offset:0x5c3c
    s_buffer_load_dwordx2 s[100:101], s[48:51], s24 offset:0x5d3c
    s_buffer_load_dwordx2 s[100:101], s[48:51], s24 offset:0x5e3c
    s_buffer_load_dwordx2 s[100:101], s[48:51], s24 offset:0x5f3c
    s_buffer_load_dwordx2 s[100:101], s[48:51], s24 offset:0x603c
    s_buffer_load_dwordx2 s[100:101], s[48:51], s24 offset:0x613c
    s_waitcnt lgkmcnt(0)
    s_lshr_b32 s24, s2, 3
    s_mul_i32 s24, s24, 44032
    s_lshl_b32 s27, s35, 7
    s_add_u32 s24, s24, s27
    s_buffer_load_dwordx2 s[100:101], s[48:51], s24 offset:0x693c
    s_buffer_load_dwordx2 s[100:101], s[48:51], s24 offset:0x6a3c
    s_buffer_load_dwordx2 s[100:101], s[48:51], s24 offset:0x6b3c
    s_buffer_load_dwordx2 s[100:101], s[48:51], s24 offset:0x6c3c
    s_buffer_load_dwordx2 s[100:101], s[48:51], s24 offset:0x6d3c
    s_buffer_load_dwordx2 s[100:101], s[48:51], s24 offset:0x6e3c
    s_buffer_load_dwordx2 s[100:101], s[48:51], s24 offset:0x6f3c
    s_barrier
    s_add_u32 m0, s32, 0x0
    s_mov_b32 s30, 0x0
    buffer_load_dwordx4 v7, s[44:47], s30 offen lds
    s_add_u32 m0, s32, 0x800
    s_mov_b32 s30, 0x40
    buffer_load_dwordx4 v7, s[44:47], s30 offen lds
    s_add_u32 m0, s32, 0x1000
    s_mov_b32 s30, 0x80
    buffer_load_dwordx4 v7, s[44:47], s30 offen lds
    s_add_u32 m0, s32, 0x1800
    s_mov_b32 s30, 0x15800
    buffer_load_dwordx4 v7, s[44:47], s30 offen lds
    s_add_u32 m0, s32, 0x2000
    s_mov_b32 s30, 0x15840
    buffer_load_dwordx4 v7, s[44:47], s30 offen lds
    s_add_u32 m0, s32, 0x2800
    s_mov_b32 s30, 0x15880
    buffer_load_dwordx4 v7, s[44:47], s30 offen lds
    s_add_u32 m0, s32, 0x3000
    s_mov_b32 s30, 0x2b000
    buffer_load_dwordx4 v7, s[44:47], s30 offen lds
    s_add_u32 m0, s32, 0x3800
    s_mov_b32 s30, 0x2b040
    buffer_load_dwordx4 v7, s[44:47], s30 offen lds
    s_add_u32 m0, s32, 0x4000
    s_mov_b32 s30, 0x2b080
    buffer_load_dwordx4 v7, s[44:47], s30 offen lds
    s_add_u32 m0, s32, 0x4800
    s_mov_b32 s30, 0x40800
    buffer_load_dwordx4 v7, s[44:47], s30 offen lds
    s_add_u32 m0, s32, 0x5000
    s_mov_b32 s30, 0x40840
    buffer_load_dwordx4 v7, s[44:47], s30 offen lds
    s_add_u32 m0, s32, 0x5800
    s_mov_b32 s30, 0x40880
    buffer_load_dwordx4 v7, s[44:47], s30 offen lds
    s_add_u32 m0, s32, 0x6000
    s_mov_b32 s30, 0x56000
    buffer_load_dwordx4 v7, s[44:47], s30 offen lds
    s_add_u32 m0, s32, 0x6800
    s_mov_b32 s30, 0x56040
    buffer_load_dwordx4 v7, s[44:47], s30 offen lds
    s_add_u32 m0, s32, 0x7000
    s_mov_b32 s30, 0x56080
    buffer_load_dwordx4 v7, s[44:47], s30 offen lds
    s_lshr_b32 s24, s2, 3
    s_mul_i32 s24, s24, 44032
    s_lshl_b32 s27, s35, 7
    s_add_u32 s24, s24, s27
    s_buffer_load_dwordx2 s[100:101], s[48:51], s24 offset:0x773c
    s_buffer_load_dwordx2 s[100:101], s[48:51], s24 offset:0x783c
    s_buffer_load_dwordx2 s[100:101], s[48:51], s24 offset:0x793c
    s_buffer_load_dwordx2 s[100:101], s[48:51], s24 offset:0x7a3c
    s_buffer_load_dwordx2 s[100:101], s[48:51], s24 offset:0x7b3c
    s_buffer_load_dwordx2 s[100:101], s[48:51], s24 offset:0x7c3c
    s_buffer_load_dwordx2 s[100:101], s[48:51], s24 offset:0x7d3c
    s_waitcnt vmcnt(15)
    s_barrier
    s_add_u32 m0, s32, 0xc000
    s_mov_b32 s30, 0x6b800
    buffer_load_dwordx4 v7, s[44:47], s30 offen lds
    s_add_u32 m0, s32, 0xc800
    s_mov_b32 s30, 0x6b840
    buffer_load_dwordx4 v7, s[44:47], s30 offen lds
    s_add_u32 m0, s32, 0xd000
    s_mov_b32 s30, 0x6b880
    buffer_load_dwordx4 v7, s[44:47], s30 offen lds
    s_add_u32 m0, s32, 0xd800
    s_mov_b32 s30, 0x81000
    buffer_load_dwordx4 v7, s[44:47], s30 offen lds
    s_add_u32 m0, s32, 0xe000
    s_mov_b32 s30, 0x81040
    buffer_load_dwordx4 v7, s[44:47], s30 offen lds
    s_add_u32 m0, s32, 0xe800
    s_mov_b32 s30, 0x81080
    buffer_load_dwordx4 v7, s[44:47], s30 offen lds
    s_add_u32 m0, s32, 0xf000
    s_mov_b32 s30, 0x96800
    buffer_load_dwordx4 v7, s[44:47], s30 offen lds
    s_add_u32 m0, s32, 0xf800
    s_mov_b32 s30, 0x96840
    buffer_load_dwordx4 v7, s[44:47], s30 offen lds
    s_add_u32 m0, s32, 0x10000
    s_mov_b32 s30, 0x96880
    buffer_load_dwordx4 v7, s[44:47], s30 offen lds
    s_add_u32 m0, s32, 0x10800
    s_mov_b32 s30, 0xac000
    buffer_load_dwordx4 v7, s[44:47], s30 offen lds
    s_add_u32 m0, s32, 0x11000
    s_mov_b32 s30, 0xac040
    buffer_load_dwordx4 v7, s[44:47], s30 offen lds
    s_add_u32 m0, s32, 0x11800
    s_mov_b32 s30, 0xac080
    buffer_load_dwordx4 v7, s[44:47], s30 offen lds
    s_add_u32 m0, s32, 0x25000
    s_mov_b32 s30, 0xc1800
    buffer_load_dwordx4 v7, s[44:47], s30 offen lds
    s_add_u32 m0, s32, 0x25800
    s_mov_b32 s30, 0xc1840
    buffer_load_dwordx4 v7, s[44:47], s30 offen lds
    s_add_u32 m0, s32, 0x26000
    s_mov_b32 s30, 0xc1880
    buffer_load_dwordx4 v7, s[44:47], s30 offen lds
    s_lshr_b32 s24, s2, 3
    s_mul_i32 s24, s24, 44032
    s_lshl_b32 s27, s35, 7
    s_add_u32 s24, s24, s27
    s_buffer_load_dwordx2 s[100:101], s[48:51], s24 offset:0x853c
    s_buffer_load_dwordx2 s[100:101], s[48:51], s24 offset:0x863c
    s_buffer_load_dwordx2 s[100:101], s[48:51], s24 offset:0x873c
    s_buffer_load_dwordx2 s[100:101], s[48:51], s24 offset:0x883c
    s_buffer_load_dwordx2 s[100:101], s[48:51], s24 offset:0x893c
    s_buffer_load_dwordx2 s[100:101], s[48:51], s24 offset:0x8a3c
    s_buffer_load_dwordx2 s[100:101], s[48:51], s24 offset:0x8b3c
    s_waitcnt lgkmcnt(0)
    s_lshr_b32 s24, s2, 3
    s_mul_i32 s24, s24, 44032
    s_lshl_b32 s27, s35, 7
    s_add_u32 s24, s24, s27
    s_buffer_load_dwordx2 s[100:101], s[48:51], s24 offset:0x933c
    s_buffer_load_dwordx2 s[100:101], s[48:51], s24 offset:0x943c
    s_buffer_load_dwordx2 s[100:101], s[48:51], s24 offset:0x953c
    s_buffer_load_dwordx2 s[100:101], s[48:51], s24 offset:0x963c
    s_buffer_load_dwordx2 s[100:101], s[48:51], s24 offset:0x973c
    s_buffer_load_dwordx2 s[100:101], s[48:51], s24 offset:0x983c
    s_buffer_load_dwordx2 s[100:101], s[48:51], s24 offset:0x993c
    s_barrier
    s_add_u32 m0, s32, 0x22000
    s_mov_b32 s30, 0xd7000
    buffer_load_dwordx4 v7, s[44:47], s30 offen lds
    s_add_u32 m0, s32, 0x22800
    s_mov_b32 s30, 0xd7040
    buffer_load_dwordx4 v7, s[44:47], s30 offen lds
    s_add_u32 m0, s32, 0x23000
    s_mov_b32 s30, 0xd7080
    buffer_load_dwordx4 v7, s[44:47], s30 offen lds
    s_add_u32 m0, s32, 0x23800
    s_mov_b32 s30, 0xec800
    buffer_load_dwordx4 v7, s[44:47], s30 offen lds
    s_add_u32 m0, s32, 0x24000
    s_mov_b32 s30, 0xec840
    buffer_load_dwordx4 v7, s[44:47], s30 offen lds
    s_add_u32 m0, s32, 0x24800
    s_mov_b32 s30, 0xec880
    buffer_load_dwordx4 v7, s[44:47], s30 offen lds
    s_lshr_b32 s24, s2, 3
    s_mul_i32 s24, s24, 44032
    s_lshl_b32 s27, s35, 7
    s_add_u32 s24, s24, s27
    s_buffer_load_dwordx2 s[100:101], s[48:51], s24 offset:0xa13c
    s_buffer_load_dwordx2 s[100:101], s[48:51], s24 offset:0xa23c
    s_buffer_load_dwordx2 s[100:101], s[48:51], s24 offset:0xa33c
    s_buffer_load_dwordx2 s[100:101], s[48:51], s24 offset:0xa43c
    s_buffer_load_dwordx2 s[100:101], s[48:51], s24 offset:0xa53c
    s_buffer_load_dwordx2 s[100:101], s[48:51], s24 offset:0xa63c
    s_buffer_load_dwordx2 s[100:101], s[48:51], s24 offset:0xa73c
    s_waitcnt vmcnt(33)
    s_barrier
    s_add_u32 m0, s32, 0x7800
    s_mov_b32 s30, 0x102000
    buffer_load_dwordx4 v7, s[44:47], s30 offen lds
    s_add_u32 m0, s32, 0x8000
    s_mov_b32 s30, 0x102040
    buffer_load_dwordx4 v7, s[44:47], s30 offen lds
    s_add_u32 m0, s32, 0x8800
    s_mov_b32 s30, 0x102080
    buffer_load_dwordx4 v7, s[44:47], s30 offen lds
    s_add_u32 m0, s32, 0x9000
    s_mov_b32 s30, 0x117800
    buffer_load_dwordx4 v7, s[44:47], s30 offen lds
    s_add_u32 m0, s32, 0x9800
    s_mov_b32 s30, 0x117840
    buffer_load_dwordx4 v7, s[44:47], s30 offen lds
    s_add_u32 m0, s32, 0xa000
    s_mov_b32 s30, 0x117880
    buffer_load_dwordx4 v7, s[44:47], s30 offen lds
    s_add_u32 m0, s32, 0xa800
    s_mov_b32 s30, 0x12d000
    buffer_load_dwordx4 v7, s[44:47], s30 offen lds
    s_add_u32 m0, s32, 0xb000
    s_mov_b32 s30, 0x12d040
    buffer_load_dwordx4 v7, s[44:47], s30 offen lds
    s_add_u32 m0, s32, 0xb800
    s_mov_b32 s30, 0x12d080
    buffer_load_dwordx4 v7, s[44:47], s30 offen lds
    s_lshr_b32 s24, s2, 3
    s_and_b32 s27, s2, 7
    s_lshl_b32 s27, s27, 5
    s_add_u32 s24, s24, s27
    s_and_b32 s27, s24, 1
    s_mul_i32 s27, s27, 13824
    s_lshr_b32 s24, s24, 1
    s_lshl_b32 s24, s24, 16
    s_add_u32 s24, s24, s27
    s_add_u32 s24, s24, 16384
    s_lshl_b32 s27, s35, 7
    s_add_u32 s24, s24, s27
    s_buffer_load_dwordx2 s[100:101], s[16:19], s24 offset:0x33c
    s_buffer_load_dwordx2 s[100:101], s[16:19], s24 offset:0x43c
    s_buffer_load_dwordx2 s[100:101], s[16:19], s24 offset:0x53c
    s_buffer_load_dwordx2 s[100:101], s[16:19], s24 offset:0x63c
    s_buffer_load_dwordx2 s[100:101], s[16:19], s24 offset:0x73c
    s_buffer_load_dwordx2 s[100:101], s[16:19], s24 offset:0x83c
    s_buffer_load_dwordx2 s[100:101], s[16:19], s24 offset:0x93c
    s_waitcnt vmcnt(39)
    s_barrier
    s_waitcnt vmcnt(33)
    s_barrier
    s_add_u32 m0, s32, 0x0
    s_mov_b32 s30, 0x142800
    buffer_load_dwordx4 v7, s[44:47], s30 offen lds
    s_add_u32 m0, s32, 0x800
    s_mov_b32 s30, 0x142840
    buffer_load_dwordx4 v7, s[44:47], s30 offen lds
    s_add_u32 m0, s32, 0x1000
    s_mov_b32 s30, 0x142880
    buffer_load_dwordx4 v7, s[44:47], s30 offen lds
    s_waitcnt vmcnt(30)
    s_barrier
    s_add_u32 m0, s32, 0x2000
    s_mov_b32 s30, 0x0
    buffer_load_dwordx4 v12, s[48:51], s30 offen lds
    s_add_u32 m0, s32, 0x2800
    s_mov_b32 s30, 0x4000
    buffer_load_dwordx4 v12, s[48:51], s30 offen lds
    s_add_u32 m0, s32, 0x3000
    s_mov_b32 s30, 0x8000
    buffer_load_dwordx4 v12, s[48:51], s30 offen lds
    s_add_u32 m0, s32, 0x3800
    s_mov_b32 s30, 0xc000
    buffer_load_dwordx4 v12, s[48:51], s30 offen lds
    s_waitcnt vmcnt(28)
    s_barrier
    s_add_u32 m0, s32, 0x4000
    s_mov_b32 s30, 0x10000
    buffer_load_dwordx4 v12, s[48:51], s30 offen lds
    s_add_u32 m0, s32, 0x4800
    s_mov_b32 s30, 0x14000
    buffer_load_dwordx4 v12, s[48:51], s30 offen lds
    s_add_u32 m0, s32, 0x5000
    s_mov_b32 s30, 0x18000
    buffer_load_dwordx4 v12, s[48:51], s30 offen lds
    s_add_u32 m0, s32, 0x5800
    s_mov_b32 s30, 0x1c000
    buffer_load_dwordx4 v12, s[48:51], s30 offen lds
    s_lshr_b32 s24, s2, 3
    s_and_b32 s27, s2, 7
    s_lshl_b32 s27, s27, 5
    s_add_u32 s24, s24, s27
    s_and_b32 s27, s24, 1
    s_mul_i32 s27, s27, 13824
    s_lshr_b32 s24, s24, 1
    s_lshl_b32 s24, s24, 16
    s_add_u32 s24, s24, s27
    s_add_u32 s24, s24, 16384
    s_lshl_b32 s27, s35, 7
    s_add_u32 s24, s24, s27
    s_buffer_load_dwordx2 s[100:101], s[16:19], s24 offset:0x113c
    s_buffer_load_dwordx2 s[100:101], s[16:19], s24 offset:0x123c
    s_buffer_load_dwordx2 s[100:101], s[16:19], s24 offset:0x133c
    s_buffer_load_dwordx2 s[100:101], s[16:19], s24 offset:0x143c
    s_buffer_load_dwordx2 s[100:101], s[16:19], s24 offset:0x153c
    s_buffer_load_dwordx2 s[100:101], s[16:19], s24 offset:0x163c
    s_buffer_load_dwordx2 s[100:101], s[16:19], s24 offset:0x173c
    s_waitcnt vmcnt(26)
    s_barrier
    s_add_u32 m0, s32, 0xc000
    s_mov_b32 s30, 0x20000
    buffer_load_dwordx4 v12, s[48:51], s30 offen lds
    s_add_u32 m0, s32, 0xc800
    s_mov_b32 s30, 0x24000
    buffer_load_dwordx4 v12, s[48:51], s30 offen lds
    s_add_u32 m0, s32, 0xd000
    s_mov_b32 s30, 0x28000
    buffer_load_dwordx4 v12, s[48:51], s30 offen lds
    s_add_u32 m0, s32, 0xd800
    s_mov_b32 s30, 0x2c000
    buffer_load_dwordx4 v12, s[48:51], s30 offen lds
    s_waitcnt vmcnt(24)
    s_barrier
    s_add_u32 m0, s32, 0xe000
    s_mov_b32 s30, 0x30000
    buffer_load_dwordx4 v12, s[48:51], s30 offen lds
    s_add_u32 m0, s32, 0xe800
    s_mov_b32 s30, 0x34000
    buffer_load_dwordx4 v12, s[48:51], s30 offen lds
    s_add_u32 m0, s32, 0xf000
    s_mov_b32 s30, 0x38000
    buffer_load_dwordx4 v12, s[48:51], s30 offen lds
    s_add_u32 m0, s32, 0xf800
    s_mov_b32 s30, 0x3c000
    buffer_load_dwordx4 v12, s[48:51], s30 offen lds
    s_add_u32 m0, s32, 0x10000
    s_mov_b32 s30, 0x40000
    buffer_load_dwordx4 v12, s[48:51], s30 offen lds
    s_add_u32 m0, s32, 0x10800
    s_mov_b32 s30, 0x44000
    buffer_load_dwordx4 v12, s[48:51], s30 offen lds
    s_add_u32 m0, s32, 0x11000
    s_mov_b32 s30, 0x48000
    buffer_load_dwordx4 v12, s[48:51], s30 offen lds
    s_add_u32 m0, s32, 0x11800
    s_mov_b32 s30, 0x4c000
    buffer_load_dwordx4 v12, s[48:51], s30 offen lds
    s_add_u32 m0, s32, 0x12000
    s_mov_b32 s30, 0x50000
    buffer_load_dwordx4 v12, s[48:51], s30 offen lds
    s_add_u32 m0, s32, 0x12800
    s_mov_b32 s30, 0x54000
    buffer_load_dwordx4 v12, s[48:51], s30 offen lds
    s_add_u32 m0, s32, 0x13000
    s_mov_b32 s30, 0x58000
    buffer_load_dwordx4 v12, s[48:51], s30 offen lds
    s_add_u32 m0, s32, 0x13800
    s_mov_b32 s30, 0x5c000
    buffer_load_dwordx4 v12, s[48:51], s30 offen lds
    s_waitcnt vmcnt(30)
    s_barrier
    s_add_u32 m0, s32, 0x14000
    s_mov_b32 s30, 0x60000
    buffer_load_dwordx4 v12, s[48:51], s30 offen lds
    s_add_u32 m0, s32, 0x14800
    s_mov_b32 s30, 0x64000
    buffer_load_dwordx4 v12, s[48:51], s30 offen lds
    s_add_u32 m0, s32, 0x15000
    s_mov_b32 s30, 0x68000
    buffer_load_dwordx4 v12, s[48:51], s30 offen lds
    s_add_u32 m0, s32, 0x15800
    s_mov_b32 s30, 0x6c000
    buffer_load_dwordx4 v12, s[48:51], s30 offen lds
    s_add_u32 m0, s32, 0x16000
    s_mov_b32 s30, 0x70000
    buffer_load_dwordx4 v12, s[48:51], s30 offen lds
    s_add_u32 m0, s32, 0x16800
    s_mov_b32 s30, 0x74000
    buffer_load_dwordx4 v12, s[48:51], s30 offen lds
    s_add_u32 m0, s32, 0x17000
    s_mov_b32 s30, 0x78000
    buffer_load_dwordx4 v12, s[48:51], s30 offen lds
    s_add_u32 m0, s32, 0x17800
    s_mov_b32 s30, 0x7c000
    buffer_load_dwordx4 v12, s[48:51], s30 offen lds
    s_lshr_b32 s24, s2, 3
    s_and_b32 s27, s2, 7
    s_lshl_b32 s27, s27, 5
    s_add_u32 s24, s24, s27
    s_and_b32 s27, s24, 1
    s_mul_i32 s27, s27, 13824
    s_lshr_b32 s24, s24, 1
    s_lshl_b32 s24, s24, 16
    s_add_u32 s24, s24, s27
    s_add_u32 s24, s24, 16384
    s_lshl_b32 s27, s35, 7
    s_add_u32 s24, s24, s27
    s_buffer_load_dwordx2 s[100:101], s[16:19], s24 offset:0x1f3c
    s_buffer_load_dwordx2 s[100:101], s[16:19], s24 offset:0x203c
    s_buffer_load_dwordx2 s[100:101], s[16:19], s24 offset:0x213c
    s_buffer_load_dwordx2 s[100:101], s[16:19], s24 offset:0x223c
    s_buffer_load_dwordx2 s[100:101], s[16:19], s24 offset:0x233c
    s_buffer_load_dwordx2 s[100:101], s[16:19], s24 offset:0x243c
    s_buffer_load_dwordx2 s[100:101], s[16:19], s24 offset:0x253c
    s_waitcnt vmcnt(32)
    s_barrier
    s_add_u32 m0, s32, 0x6000
    s_mov_b32 s30, 0x80000
    buffer_load_dwordx4 v12, s[48:51], s30 offen lds
    s_add_u32 m0, s32, 0x6800
    s_mov_b32 s30, 0x84000
    buffer_load_dwordx4 v12, s[48:51], s30 offen lds
    s_add_u32 m0, s32, 0x7000
    s_mov_b32 s30, 0x88000
    buffer_load_dwordx4 v12, s[48:51], s30 offen lds
    s_add_u32 m0, s32, 0x7800
    s_mov_b32 s30, 0x8c000
    buffer_load_dwordx4 v12, s[48:51], s30 offen lds
    s_add_u32 m0, s32, 0x18000
    s_mov_b32 s30, 0x90000
    buffer_load_dwordx4 v12, s[48:51], s30 offen lds
    s_add_u32 m0, s32, 0x18800
    s_mov_b32 s30, 0x94000
    buffer_load_dwordx4 v12, s[48:51], s30 offen lds
    s_add_u32 m0, s32, 0x19000
    s_mov_b32 s30, 0x98000
    buffer_load_dwordx4 v12, s[48:51], s30 offen lds
    s_add_u32 m0, s32, 0x19800
    s_mov_b32 s30, 0x9c000
    buffer_load_dwordx4 v12, s[48:51], s30 offen lds
    s_add_u32 m0, s32, 0x1a000
    s_mov_b32 s30, 0xa0000
    buffer_load_dwordx4 v12, s[48:51], s30 offen lds
    s_add_u32 m0, s32, 0x1a800
    s_mov_b32 s30, 0xa4000
    buffer_load_dwordx4 v12, s[48:51], s30 offen lds
    s_add_u32 m0, s32, 0x1b000
    s_mov_b32 s30, 0xa8000
    buffer_load_dwordx4 v12, s[48:51], s30 offen lds
    s_add_u32 m0, s32, 0x1b800
    s_mov_b32 s30, 0xac000
    buffer_load_dwordx4 v12, s[48:51], s30 offen lds
    s_add_u32 m0, s32, 0x22000
    s_mov_b32 s30, 0xb0000
    buffer_load_dwordx4 v12, s[48:51], s30 offen lds
    s_add_u32 m0, s32, 0x22800
    s_mov_b32 s30, 0xb4000
    buffer_load_dwordx4 v12, s[48:51], s30 offen lds
    s_add_u32 m0, s32, 0x23000
    s_mov_b32 s30, 0xb8000
    buffer_load_dwordx4 v12, s[48:51], s30 offen lds
    s_add_u32 m0, s32, 0x23800
    s_mov_b32 s30, 0xbc000
    buffer_load_dwordx4 v12, s[48:51], s30 offen lds
    s_add_u32 m0, s32, 0x24000
    s_mov_b32 s30, 0xc0000
    buffer_load_dwordx4 v12, s[48:51], s30 offen lds
    s_add_u32 m0, s32, 0x24800
    s_mov_b32 s30, 0xc4000
    buffer_load_dwordx4 v12, s[48:51], s30 offen lds
    s_add_u32 m0, s32, 0x25000
    s_mov_b32 s30, 0xc8000
    buffer_load_dwordx4 v12, s[48:51], s30 offen lds
    s_add_u32 m0, s32, 0x25800
    s_mov_b32 s30, 0xcc000
    buffer_load_dwordx4 v12, s[48:51], s30 offen lds
    s_waitcnt vmcnt(44)
    s_barrier
    s_add_u32 m0, s32, 0x0
    s_mov_b32 s30, 0xd0000
    buffer_load_dwordx4 v12, s[48:51], s30 offen lds
    s_add_u32 m0, s32, 0x800
    s_mov_b32 s30, 0xd4000
    buffer_load_dwordx4 v12, s[48:51], s30 offen lds
    s_add_u32 m0, s32, 0x1000
    s_mov_b32 s30, 0xd8000
    buffer_load_dwordx4 v12, s[48:51], s30 offen lds
    s_add_u32 m0, s32, 0x1800
    s_mov_b32 s30, 0xdc000
    buffer_load_dwordx4 v12, s[48:51], s30 offen lds
    s_add_u32 m0, s32, 0x8000
    s_mov_b32 s30, 0xe0000
    buffer_load_dwordx4 v12, s[48:51], s30 offen lds
    s_add_u32 m0, s32, 0x8800
    s_mov_b32 s30, 0xe4000
    buffer_load_dwordx4 v12, s[48:51], s30 offen lds
    s_add_u32 m0, s32, 0x9000
    s_mov_b32 s30, 0xe8000
    buffer_load_dwordx4 v12, s[48:51], s30 offen lds
    s_add_u32 m0, s32, 0x9800
    s_mov_b32 s30, 0xec000
    buffer_load_dwordx4 v12, s[48:51], s30 offen lds
    s_add_u32 m0, s32, 0xa000
    s_mov_b32 s30, 0xf0000
    buffer_load_dwordx4 v12, s[48:51], s30 offen lds
    s_add_u32 m0, s32, 0xa800
    s_mov_b32 s30, 0xf4000
    buffer_load_dwordx4 v12, s[48:51], s30 offen lds
    s_add_u32 m0, s32, 0xb000
    s_mov_b32 s30, 0xf8000
    buffer_load_dwordx4 v12, s[48:51], s30 offen lds
    s_add_u32 m0, s32, 0xb800
    s_mov_b32 s30, 0xfc000
    buffer_load_dwordx4 v12, s[48:51], s30 offen lds
    s_add_u32 m0, s32, 0x1c000
    s_mov_b32 s30, 0x100000
    buffer_load_dwordx4 v12, s[48:51], s30 offen lds
    s_add_u32 m0, s32, 0x1c800
    s_mov_b32 s30, 0x104000
    buffer_load_dwordx4 v12, s[48:51], s30 offen lds
    s_add_u32 m0, s32, 0x1d000
    s_mov_b32 s30, 0x108000
    buffer_load_dwordx4 v12, s[48:51], s30 offen lds
    s_add_u32 m0, s32, 0x1d800
    s_mov_b32 s30, 0x10c000
    buffer_load_dwordx4 v12, s[48:51], s30 offen lds
    s_add_u32 m0, s32, 0x1e000
    s_mov_b32 s30, 0x110000
    buffer_load_dwordx4 v12, s[48:51], s30 offen lds
    s_add_u32 m0, s32, 0x1e800
    s_mov_b32 s30, 0x114000
    buffer_load_dwordx4 v12, s[48:51], s30 offen lds
    s_add_u32 m0, s32, 0x1f000
    s_mov_b32 s30, 0x118000
    buffer_load_dwordx4 v12, s[48:51], s30 offen lds
    s_add_u32 m0, s32, 0x1f800
    s_mov_b32 s30, 0x11c000
    buffer_load_dwordx4 v12, s[48:51], s30 offen lds
    s_add_u32 m0, s32, 0x20000
    s_mov_b32 s30, 0x120000
    buffer_load_dwordx4 v12, s[48:51], s30 offen lds
    s_add_u32 m0, s32, 0x20800
    s_mov_b32 s30, 0x124000
    buffer_load_dwordx4 v12, s[48:51], s30 offen lds
    s_add_u32 m0, s32, 0x21000
    s_mov_b32 s30, 0x128000
    buffer_load_dwordx4 v12, s[48:51], s30 offen lds
    s_add_u32 m0, s32, 0x21800
    s_mov_b32 s30, 0x12c000
    buffer_load_dwordx4 v12, s[48:51], s30 offen lds
    s_waitcnt vmcnt(24)
    s_barrier
    s_add_u32 m0, s32, 0x26000
    s_mov_b32 s30, 0x130000
    buffer_load_dwordx4 v12, s[48:51], s30 offen lds
    s_add_u32 m0, s32, 0x26800
    s_mov_b32 s30, 0x134000
    buffer_load_dwordx4 v12, s[48:51], s30 offen lds
    s_add_u32 m0, s32, 0x27000
    s_mov_b32 s30, 0x138000
    buffer_load_dwordx4 v12, s[48:51], s30 offen lds
    s_add_u32 m0, s32, 0x27800
    s_mov_b32 s30, 0x13c000
    buffer_load_dwordx4 v12, s[48:51], s30 offen lds
    s_add_u32 m0, s32, 0x2000
    s_mov_b32 s30, 0x140000
    buffer_load_dwordx4 v12, s[48:51], s30 offen lds
    s_add_u32 m0, s32, 0x2800
    s_mov_b32 s30, 0x144000
    buffer_load_dwordx4 v12, s[48:51], s30 offen lds
    s_add_u32 m0, s32, 0x3000
    s_mov_b32 s30, 0x148000
    buffer_load_dwordx4 v12, s[48:51], s30 offen lds
    s_add_u32 m0, s32, 0x3800
    s_mov_b32 s30, 0x14c000
    buffer_load_dwordx4 v12, s[48:51], s30 offen lds
    s_add_u32 m0, s32, 0x4000
    s_mov_b32 s30, 0x150000
    buffer_load_dwordx4 v12, s[48:51], s30 offen lds
    s_add_u32 m0, s32, 0x4800
    s_mov_b32 s30, 0x154000
    buffer_load_dwordx4 v12, s[48:51], s30 offen lds
    s_waitcnt vmcnt(0) lgkmcnt(0)
    s_barrier
    s_endpgm
prod_a:
    s_sub_u32 s35, s20, 10
    s_mul_i32 s32, s35, 4096
    s_mul_i32 s31, s35, 64
    s_add_u32 s31, s31, s21
    s_lshl_b32 s31, s31, 10
    v_lshlrev_b32 v15, 1, v2
    v_mov_b32 v14, 0x78
    v_lshrrev_b32 v15, v15, v14
    v_and_b32 v15, 3, v15
    v_xor_b32 v15, v15, v5
    v_lshrrev_b32 v7, 2, v1
    v_lshlrev_b32 v7, 10, v7
    v_lshl_add_u32 v7, v15, 4, v7
    v_add_u32 v7, s31, v7
    v_lshlrev_b32 v23, 2, v1
    s_add_u32 s29, s39, 0
    s_and_b32 s29, s29, 15
    s_lshl_b32 s29, s29, 6
    s_add_u32 m0, s32, 0x1800
    s_add_u32 s30, s29, 0x0
    buffer_load_dwordx4 v7, s[4:7], s30 offen lds
    s_add_u32 m0, s32, 0x1c00
    s_add_u32 s30, s29, 0x4000
    buffer_load_dwordx4 v7, s[4:7], s30 offen lds
    s_add_u32 m0, s32, 0x2000
    s_add_u32 s30, s29, 0x8000
    buffer_load_dwordx4 v7, s[4:7], s30 offen lds
    s_add_u32 m0, s32, 0x2400
    s_add_u32 s30, s29, 0xc000
    buffer_load_dwordx4 v7, s[4:7], s30 offen lds
    s_add_u32 s29, s39, 1
    s_and_b32 s29, s29, 15
    s_lshl_b32 s29, s29, 6
    s_add_u32 m0, s32, 0x5000
    s_add_u32 s30, s29, 0x0
    buffer_load_dwordx4 v7, s[4:7], s30 offen lds
    s_add_u32 m0, s32, 0x5400
    s_add_u32 s30, s29, 0x4000
    buffer_load_dwordx4 v7, s[4:7], s30 offen lds
    s_add_u32 m0, s32, 0x5800
    s_add_u32 s30, s29, 0x8000
    buffer_load_dwordx4 v7, s[4:7], s30 offen lds
    s_add_u32 m0, s32, 0x5c00
    s_add_u32 s30, s29, 0xc000
    buffer_load_dwordx4 v7, s[4:7], s30 offen lds
    s_add_u32 s29, s39, 2
    s_and_b32 s29, s29, 15
    s_lshl_b32 s29, s29, 6
    s_add_u32 m0, s32, 0x8800
    s_add_u32 s30, s29, 0x0
    buffer_load_dwordx4 v7, s[4:7], s30 offen lds
    s_add_u32 m0, s32, 0x8c00
    s_add_u32 s30, s29, 0x4000
    buffer_load_dwordx4 v7, s[4:7], s30 offen lds
    s_add_u32 m0, s32, 0x9000
    s_add_u32 s30, s29, 0x8000
    buffer_load_dwordx4 v7, s[4:7], s30 offen lds
    s_add_u32 m0, s32, 0x9400
    s_add_u32 s30, s29, 0xc000
    buffer_load_dwordx4 v7, s[4:7], s30 offen lds
    s_add_u32 s29, s39, 3
    s_and_b32 s29, s29, 15
    s_lshl_b32 s29, s29, 6
    s_add_u32 m0, s32, 0xc000
    s_add_u32 s30, s29, 0x0
    buffer_load_dwordx4 v7, s[4:7], s30 offen lds
    s_add_u32 m0, s32, 0xc400
    s_add_u32 s30, s29, 0x4000
    buffer_load_dwordx4 v7, s[4:7], s30 offen lds
    s_add_u32 m0, s32, 0xc800
    s_add_u32 s30, s29, 0x8000
    buffer_load_dwordx4 v7, s[4:7], s30 offen lds
    s_add_u32 m0, s32, 0xcc00
    s_add_u32 s30, s29, 0xc000
    buffer_load_dwordx4 v7, s[4:7], s30 offen lds
    s_add_u32 s29, s39, 4
    s_and_b32 s29, s29, 15
    s_lshl_b32 s29, s29, 6
    s_add_u32 m0, s32, 0xf800
    s_add_u32 s30, s29, 0x0
    buffer_load_dwordx4 v7, s[4:7], s30 offen lds
    s_add_u32 m0, s32, 0xfc00
    s_add_u32 s30, s29, 0x4000
    buffer_load_dwordx4 v7, s[4:7], s30 offen lds
    s_add_u32 m0, s32, 0x10000
    s_add_u32 s30, s29, 0x8000
    buffer_load_dwordx4 v7, s[4:7], s30 offen lds
    s_add_u32 m0, s32, 0x10400
    s_add_u32 s30, s29, 0xc000
    buffer_load_dwordx4 v7, s[4:7], s30 offen lds
    v_mov_b32 v24, 0
    v_mov_b32 v25, 0x27800
    ds_write_b32 v25, v24
    s_waitcnt lgkmcnt(0)
    s_waitcnt vmcnt(16)
    s_barrier
    s_add_u32 s29, s39, 5
    s_and_b32 s29, s29, 15
    s_lshl_b32 s29, s29, 6
    s_add_u32 m0, s32, 0x13000
    s_add_u32 s30, s29, 0x0
    buffer_load_dwordx4 v7, s[4:7], s30 offen lds
    s_add_u32 m0, s32, 0x13400
    s_add_u32 s30, s29, 0x4000
    buffer_load_dwordx4 v7, s[4:7], s30 offen lds
    s_add_u32 m0, s32, 0x13800
    s_add_u32 s30, s29, 0x8000
    buffer_load_dwordx4 v7, s[4:7], s30 offen lds
    s_add_u32 m0, s32, 0x13c00
    s_add_u32 s30, s29, 0xc000
    buffer_load_dwordx4 v7, s[4:7], s30 offen lds
    s_and_b32 s41, s41, 0xffff
    s_mov_b32 s42, 0x80000
    s_mov_b32 s43, 0x00020000
    s_and_b32 s45, s45, 0xffff
    s_mov_b32 s46, 0x158000
    s_mov_b32 s47, 0x00020000
    s_and_b32 s49, s49, 0xffff
    s_mov_b32 s50, 0x158000
    s_mov_b32 s51, 0x00020000
    s_and_b32 s53, s53, 0xffff
    s_mov_b32 s54, 0xac0
    s_mov_b32 s55, 0x00020000
    s_and_b32 s57, s57, 0xffff
    s_mov_b32 s58, 0x400
    s_mov_b32 s59, 0x00020000
    s_and_b32 s61, s61, 0xffff
    s_mov_b32 s62, 0x200000
    s_mov_b32 s63, 0x00020000
    s_and_b32 s65, s65, 0xffff
    s_mov_b32 s66, 0x100
    s_mov_b32 s67, 0x00020000
    s_lshr_b32 s24, s2, 3
    s_mul_i32 s24, s24, 44032
    s_lshl_b32 s27, s35, 7
    s_add_u32 s24, s24, s27
    s_buffer_load_dwordx2 s[100:101], s[48:51], s24 offset:0x73c
    s_buffer_load_dwordx2 s[100:101], s[48:51], s24 offset:0x83c
    s_buffer_load_dwordx2 s[100:101], s[48:51], s24 offset:0x93c
    s_buffer_load_dwordx2 s[100:101], s[48:51], s24 offset:0xa3c
    s_buffer_load_dwordx2 s[100:101], s[48:51], s24 offset:0xb3c
    s_buffer_load_dwordx2 s[100:101], s[48:51], s24 offset:0xc3c
    s_buffer_load_dwordx2 s[100:101], s[48:51], s24 offset:0xd3c
    s_waitcnt vmcnt(16)
    s_barrier
    s_add_u32 s29, s39, 6
    s_and_b32 s29, s29, 15
    s_lshl_b32 s29, s29, 6
    s_add_u32 m0, s32, 0x16800
    s_add_u32 s30, s29, 0x0
    buffer_load_dwordx4 v7, s[4:7], s30 offen lds
    s_add_u32 m0, s32, 0x16c00
    s_add_u32 s30, s29, 0x4000
    buffer_load_dwordx4 v7, s[4:7], s30 offen lds
    s_add_u32 m0, s32, 0x17000
    s_add_u32 s30, s29, 0x8000
    buffer_load_dwordx4 v7, s[4:7], s30 offen lds
    s_add_u32 m0, s32, 0x17400
    s_add_u32 s30, s29, 0xc000
    buffer_load_dwordx4 v7, s[4:7], s30 offen lds
    s_waitcnt vmcnt(12)
    s_barrier
    s_add_u32 s29, s39, 7
    s_and_b32 s29, s29, 15
    s_lshl_b32 s29, s29, 6
    s_add_u32 m0, s32, 0x1a000
    s_add_u32 s30, s29, 0x0
    buffer_load_dwordx4 v7, s[4:7], s30 offen lds
    s_add_u32 m0, s32, 0x1a400
    s_add_u32 s30, s29, 0x4000
    buffer_load_dwordx4 v7, s[4:7], s30 offen lds
    s_add_u32 m0, s32, 0x1a800
    s_add_u32 s30, s29, 0x8000
    buffer_load_dwordx4 v7, s[4:7], s30 offen lds
    s_add_u32 m0, s32, 0x1ac00
    s_add_u32 s30, s29, 0xc000
    buffer_load_dwordx4 v7, s[4:7], s30 offen lds
    s_add_u32 s29, s39, 8
    s_and_b32 s29, s29, 15
    s_lshl_b32 s29, s29, 6
    s_add_u32 m0, s32, 0x1d800
    s_add_u32 s30, s29, 0x0
    buffer_load_dwordx4 v7, s[4:7], s30 offen lds
    s_add_u32 m0, s32, 0x1dc00
    s_add_u32 s30, s29, 0x4000
    buffer_load_dwordx4 v7, s[4:7], s30 offen lds
    s_add_u32 m0, s32, 0x1e000
    s_add_u32 s30, s29, 0x8000
    buffer_load_dwordx4 v7, s[4:7], s30 offen lds
    s_add_u32 m0, s32, 0x1e400
    s_add_u32 s30, s29, 0xc000
    buffer_load_dwordx4 v7, s[4:7], s30 offen lds
    s_lshr_b32 s24, s2, 3
    s_mul_i32 s24, s24, 44032
    s_lshl_b32 s27, s35, 7
    s_add_u32 s24, s24, s27
    s_buffer_load_dwordx2 s[100:101], s[48:51], s24 offset:0x153c
    s_buffer_load_dwordx2 s[100:101], s[48:51], s24 offset:0x163c
    s_buffer_load_dwordx2 s[100:101], s[48:51], s24 offset:0x173c
    s_buffer_load_dwordx2 s[100:101], s[48:51], s24 offset:0x183c
    s_buffer_load_dwordx2 s[100:101], s[48:51], s24 offset:0x193c
    s_buffer_load_dwordx2 s[100:101], s[48:51], s24 offset:0x1a3c
    s_buffer_load_dwordx2 s[100:101], s[48:51], s24 offset:0x1b3c
    s_waitcnt vmcnt(12)
    s_barrier
    s_add_u32 s29, s39, 9
    s_and_b32 s29, s29, 15
    s_lshl_b32 s29, s29, 6
    s_add_u32 m0, s32, 0x21000
    s_add_u32 s30, s29, 0x0
    buffer_load_dwordx4 v7, s[4:7], s30 offen lds
    s_add_u32 m0, s32, 0x21400
    s_add_u32 s30, s29, 0x4000
    buffer_load_dwordx4 v7, s[4:7], s30 offen lds
    s_add_u32 m0, s32, 0x21800
    s_add_u32 s30, s29, 0x8000
    buffer_load_dwordx4 v7, s[4:7], s30 offen lds
    s_add_u32 m0, s32, 0x21c00
    s_add_u32 s30, s29, 0xc000
    buffer_load_dwordx4 v7, s[4:7], s30 offen lds
    s_add_u32 s29, s39, 10
    s_and_b32 s29, s29, 15
    s_lshl_b32 s29, s29, 6
    s_add_u32 m0, s32, 0x24800
    s_add_u32 s30, s29, 0x0
    buffer_load_dwordx4 v7, s[4:7], s30 offen lds
    s_add_u32 m0, s32, 0x24c00
    s_add_u32 s30, s29, 0x4000
    buffer_load_dwordx4 v7, s[4:7], s30 offen lds
    s_add_u32 m0, s32, 0x25000
    s_add_u32 s30, s29, 0x8000
    buffer_load_dwordx4 v7, s[4:7], s30 offen lds
    s_add_u32 m0, s32, 0x25400
    s_add_u32 s30, s29, 0xc000
    buffer_load_dwordx4 v7, s[4:7], s30 offen lds
    s_waitcnt vmcnt(12)
    s_barrier
    s_add_u32 s29, s39, 11
    s_and_b32 s29, s29, 15
    s_lshl_b32 s29, s29, 6
    s_add_u32 m0, s32, 0x1800
    s_add_u32 s30, s29, 0x0
    buffer_load_dwordx4 v7, s[4:7], s30 offen lds
    s_add_u32 m0, s32, 0x1c00
    s_add_u32 s30, s29, 0x4000
    buffer_load_dwordx4 v7, s[4:7], s30 offen lds
    s_add_u32 m0, s32, 0x2000
    s_add_u32 s30, s29, 0x8000
    buffer_load_dwordx4 v7, s[4:7], s30 offen lds
    s_add_u32 m0, s32, 0x2400
    s_add_u32 s30, s29, 0xc000
    buffer_load_dwordx4 v7, s[4:7], s30 offen lds
    s_add_u32 s29, s39, 12
    s_and_b32 s29, s29, 15
    s_lshl_b32 s29, s29, 6
    s_add_u32 m0, s32, 0x5000
    s_add_u32 s30, s29, 0x0
    buffer_load_dwordx4 v7, s[4:7], s30 offen lds
    s_add_u32 m0, s32, 0x5400
    s_add_u32 s30, s29, 0x4000
    buffer_load_dwordx4 v7, s[4:7], s30 offen lds
    s_add_u32 m0, s32, 0x5800
    s_add_u32 s30, s29, 0x8000
    buffer_load_dwordx4 v7, s[4:7], s30 offen lds
    s_add_u32 m0, s32, 0x5c00
    s_add_u32 s30, s29, 0xc000
    buffer_load_dwordx4 v7, s[4:7], s30 offen lds
    s_lshr_b32 s24, s2, 3
    s_mul_i32 s24, s24, 44032
    s_lshl_b32 s27, s35, 7
    s_add_u32 s24, s24, s27
    s_buffer_load_dwordx2 s[100:101], s[48:51], s24 offset:0x233c
    s_buffer_load_dwordx2 s[100:101], s[48:51], s24 offset:0x243c
    s_buffer_load_dwordx2 s[100:101], s[48:51], s24 offset:0x253c
    s_buffer_load_dwordx2 s[100:101], s[48:51], s24 offset:0x263c
    s_buffer_load_dwordx2 s[100:101], s[48:51], s24 offset:0x273c
    s_buffer_load_dwordx2 s[100:101], s[48:51], s24 offset:0x283c
    s_buffer_load_dwordx2 s[100:101], s[48:51], s24 offset:0x293c
    s_waitcnt vmcnt(12)
    s_barrier
    s_add_u32 s29, s39, 13
    s_and_b32 s29, s29, 15
    s_lshl_b32 s29, s29, 6
    s_add_u32 m0, s32, 0x8800
    s_add_u32 s30, s29, 0x0
    buffer_load_dwordx4 v7, s[4:7], s30 offen lds
    s_add_u32 m0, s32, 0x8c00
    s_add_u32 s30, s29, 0x4000
    buffer_load_dwordx4 v7, s[4:7], s30 offen lds
    s_add_u32 m0, s32, 0x9000
    s_add_u32 s30, s29, 0x8000
    buffer_load_dwordx4 v7, s[4:7], s30 offen lds
    s_add_u32 m0, s32, 0x9400
    s_add_u32 s30, s29, 0xc000
    buffer_load_dwordx4 v7, s[4:7], s30 offen lds
    s_add_u32 s29, s39, 14
    s_and_b32 s29, s29, 15
    s_lshl_b32 s29, s29, 6
    s_add_u32 m0, s32, 0xc000
    s_add_u32 s30, s29, 0x0
    buffer_load_dwordx4 v7, s[4:7], s30 offen lds
    s_add_u32 m0, s32, 0xc400
    s_add_u32 s30, s29, 0x4000
    buffer_load_dwordx4 v7, s[4:7], s30 offen lds
    s_add_u32 m0, s32, 0xc800
    s_add_u32 s30, s29, 0x8000
    buffer_load_dwordx4 v7, s[4:7], s30 offen lds
    s_add_u32 m0, s32, 0xcc00
    s_add_u32 s30, s29, 0xc000
    buffer_load_dwordx4 v7, s[4:7], s30 offen lds
    s_waitcnt vmcnt(12)
    s_barrier
    s_add_u32 s29, s39, 15
    s_and_b32 s29, s29, 15
    s_lshl_b32 s29, s29, 6
    s_add_u32 m0, s32, 0xf800
    s_add_u32 s30, s29, 0x0
    buffer_load_dwordx4 v7, s[4:7], s30 offen lds
    s_add_u32 m0, s32, 0xfc00
    s_add_u32 s30, s29, 0x4000
    buffer_load_dwordx4 v7, s[4:7], s30 offen lds
    s_add_u32 m0, s32, 0x10000
    s_add_u32 s30, s29, 0x8000
    buffer_load_dwordx4 v7, s[4:7], s30 offen lds
    s_add_u32 m0, s32, 0x10400
    s_add_u32 s30, s29, 0xc000
    buffer_load_dwordx4 v7, s[4:7], s30 offen lds
    s_lshr_b32 s24, s2, 3
    s_mul_i32 s24, s24, 44032
    s_lshl_b32 s27, s35, 7
    s_add_u32 s24, s24, s27
    s_buffer_load_dwordx2 s[100:101], s[48:51], s24 offset:0x313c
    s_buffer_load_dwordx2 s[100:101], s[48:51], s24 offset:0x323c
    s_buffer_load_dwordx2 s[100:101], s[48:51], s24 offset:0x333c
    s_buffer_load_dwordx2 s[100:101], s[48:51], s24 offset:0x343c
    s_buffer_load_dwordx2 s[100:101], s[48:51], s24 offset:0x353c
    s_buffer_load_dwordx2 s[100:101], s[48:51], s24 offset:0x363c
    s_buffer_load_dwordx2 s[100:101], s[48:51], s24 offset:0x373c
    s_waitcnt vmcnt(8)
    s_barrier
    s_waitcnt vmcnt(0)
    s_barrier
    s_lshr_b32 s24, s2, 3
    s_mul_i32 s24, s24, 44032
    s_lshl_b32 s27, s35, 7
    s_add_u32 s24, s24, s27
    s_buffer_load_dwordx2 s[100:101], s[48:51], s24 offset:0x3f3c
    s_buffer_load_dwordx2 s[100:101], s[48:51], s24 offset:0x403c
    s_buffer_load_dwordx2 s[100:101], s[48:51], s24 offset:0x413c
    s_buffer_load_dwordx2 s[100:101], s[48:51], s24 offset:0x423c
    s_buffer_load_dwordx2 s[100:101], s[48:51], s24 offset:0x433c
    s_buffer_load_dwordx2 s[100:101], s[48:51], s24 offset:0x443c
    s_buffer_load_dwordx2 s[100:101], s[48:51], s24 offset:0x453c
    v_lshrrev_b32 v26, 1, v1
    v_lshlrev_b32 v26, 7, v26
    s_barrier
    s_lshr_b32 s24, s2, 3
    s_mul_i32 s24, s24, 44032
    s_lshl_b32 s27, s35, 7
    s_add_u32 s24, s24, s27
    s_buffer_load_dwordx2 s[100:101], s[48:51], s24 offset:0x4d3c
    s_buffer_load_dwordx2 s[100:101], s[48:51], s24 offset:0x4e3c
    s_buffer_load_dwordx2 s[100:101], s[48:51], s24 offset:0x4f3c
    s_buffer_load_dwordx2 s[100:101], s[48:51], s24 offset:0x503c
    s_buffer_load_dwordx2 s[100:101], s[48:51], s24 offset:0x513c
    s_buffer_load_dwordx2 s[100:101], s[48:51], s24 offset:0x523c
    s_buffer_load_dwordx2 s[100:101], s[48:51], s24 offset:0x533c
    s_sleep 8
    s_cmp_lg_u32 s20, 10
    s_cbranch_scc1 pa_nra
    s_cmp_lg_u32 s3, 0
    s_cbranch_scc1 pa_nra
    s_mov_b32 s28, 1
    s_mov_b32 s29, 1
    s_branch pa_r1a
pa_rpa:
    s_sleep 4
pa_r1a:
    s_sub_u32 s28, s28, 1
    s_cbranch_scc1 pa_nra
    buffer_load_dword v22, v23, s[64:67], 0 offen sc1
    s_waitcnt vmcnt(0)
    v_and_b32 v24, 0xff, v22
    v_cmp_ne_u32 vcc, 32, v24
    s_and_b32 vcc_lo, vcc_lo, 0x01010101
    s_and_b32 vcc_hi, vcc_hi, 0x01010101
    s_cmp_lg_u64 vcc, 0
    s_cbranch_scc1 pa_rpa
    s_getreg_b32 s30, hwreg(HW_REG_XCC_ID, 0, 4)
    s_mul_i32 s31, s30, s30
    s_lshl_b32 s31, s31, 23
    s_lshl_b32 s30, s30, 13
    s_add_u32 s30, s30, s31
    s_add_u32 s30, s30, 32
    v_cmp_ne_u32 vcc, s30, v22
    s_and_b32 s31, s2, 7
    s_lshl_b32 s31, s31, 3
    s_lshr_b64 s[26:27], vcc, s31
    s_and_b32 s26, s26, 1
    s_cmp_eq_u32 s26, 0
    s_cselect_b32 s29, 3, 1
pa_rda:
    s_mov_b32 s3, 1
    v_mov_b32 v24, s29
    v_mov_b32 v25, 0x27800
    ds_write_b32 v25, v24
    s_and_b32 s30, s2, 7
    s_lshl_b32 s30, s30, 8
    s_add_u32 s30, s30, 0x980000
    v_and_b32 v24, 1, v1
    v_lshlrev_b32 v24, 7, v24
    v_bfe_u32 v25, v1, 1, 2
    v_min_u32 v25, 2, v25
    v_lshl_add_u32 v24, v25, 11, v24
    buffer_load_dword v27, v24, s[16:19], s30 offen sc1
pa_nra:
    s_barrier
    s_cmp_lg_u32 s20, 10
    s_cbranch_scc1 pa_nrb
    s_cmp_lg_u32 s3, 0
    s_cbranch_scc1 pa_nrb
    s_mov_b32 s28, 16384
    s_mov_b32 s29, 1
    s_branch pa_r1b
pa_rpb:
    s_sleep 4
pa_r1b:
    s_sub_u32 s28, s28, 1
    s_cbranch_scc1 pa_rdb
    buffer_load_dword v22, v23, s[64:67], 0 offen sc1
    s_waitcnt vmcnt(0)
    v_and_b32 v24, 0xff, v22
    v_cmp_ne_u32 vcc, 32, v24
    s_and_b32 vcc_lo, vcc_lo, 0x01010101
    s_and_b32 vcc_hi, vcc_hi, 0x01010101
    s_cmp_lg_u64 vcc, 0
    s_cbranch_scc1 pa_rpb
    s_getreg_b32 s30, hwreg(HW_REG_XCC_ID, 0, 4)
    s_mul_i32 s31, s30, s30
    s_lshl_b32 s31, s31, 23
    s_lshl_b32 s30, s30, 13
    s_add_u32 s30, s30, s31
    s_add_u32 s30, s30, 32
    v_cmp_ne_u32 vcc, s30, v22
    s_and_b32 s31, s2, 7
    s_lshl_b32 s31, s31, 3
    s_lshr_b64 s[26:27], vcc, s31
    s_and_b32 s26, s26, 1
    s_cmp_eq_u32 s26, 0
    s_cselect_b32 s29, 3, 1
pa_rdb:
    s_mov_b32 s3, 1
    v_mov_b32 v24, s29
    v_mov_b32 v25, 0x27800
    ds_write_b32 v25, v24
    s_and_b32 s30, s2, 7
    s_lshl_b32 s30, s30, 8
    s_add_u32 s30, s30, 0x980000
    v_and_b32 v24, 1, v1
    v_lshlrev_b32 v24, 7, v24
    v_bfe_u32 v25, v1, 1, 2
    v_min_u32 v25, 2, v25
    v_lshl_add_u32 v24, v25, 11, v24
    buffer_load_dword v27, v24, s[16:19], s30 offen sc1
pa_nrb:
    s_lshr_b32 s24, s2, 3
    s_mul_i32 s24, s24, 44032
    s_lshl_b32 s27, s35, 7
    s_add_u32 s24, s24, s27
    s_buffer_load_dwordx2 s[100:101], s[48:51], s24 offset:0x623c
    s_buffer_load_dwordx2 s[100:101], s[48:51], s24 offset:0x633c
    s_buffer_load_dwordx2 s[100:101], s[48:51], s24 offset:0x643c
    s_buffer_load_dwordx2 s[100:101], s[48:51], s24 offset:0x653c
    s_buffer_load_dwordx2 s[100:101], s[48:51], s24 offset:0x663c
    s_buffer_load_dwordx2 s[100:101], s[48:51], s24 offset:0x673c
    s_buffer_load_dwordx2 s[100:101], s[48:51], s24 offset:0x683c
    s_waitcnt lgkmcnt(0)
    s_lshr_b32 s24, s2, 3
    s_mul_i32 s24, s24, 44032
    s_lshl_b32 s27, s35, 7
    s_add_u32 s24, s24, s27
    s_buffer_load_dwordx2 s[100:101], s[48:51], s24 offset:0x703c
    s_buffer_load_dwordx2 s[100:101], s[48:51], s24 offset:0x713c
    s_buffer_load_dwordx2 s[100:101], s[48:51], s24 offset:0x723c
    s_buffer_load_dwordx2 s[100:101], s[48:51], s24 offset:0x733c
    s_buffer_load_dwordx2 s[100:101], s[48:51], s24 offset:0x743c
    s_buffer_load_dwordx2 s[100:101], s[48:51], s24 offset:0x753c
    s_buffer_load_dwordx2 s[100:101], s[48:51], s24 offset:0x763c
    s_barrier
    s_lshr_b32 s24, s2, 3
    s_mul_i32 s24, s24, 44032
    s_lshl_b32 s27, s35, 7
    s_add_u32 s24, s24, s27
    s_buffer_load_dwordx2 s[100:101], s[48:51], s24 offset:0x7e3c
    s_buffer_load_dwordx2 s[100:101], s[48:51], s24 offset:0x7f3c
    s_buffer_load_dwordx2 s[100:101], s[48:51], s24 offset:0x803c
    s_buffer_load_dwordx2 s[100:101], s[48:51], s24 offset:0x813c
    s_buffer_load_dwordx2 s[100:101], s[48:51], s24 offset:0x823c
    s_buffer_load_dwordx2 s[100:101], s[48:51], s24 offset:0x833c
    s_buffer_load_dwordx2 s[100:101], s[48:51], s24 offset:0x843c
    s_barrier
    s_lshr_b32 s24, s2, 3
    s_mul_i32 s24, s24, 44032
    s_lshl_b32 s27, s35, 7
    s_add_u32 s24, s24, s27
    s_buffer_load_dwordx2 s[100:101], s[48:51], s24 offset:0x8c3c
    s_buffer_load_dwordx2 s[100:101], s[48:51], s24 offset:0x8d3c
    s_buffer_load_dwordx2 s[100:101], s[48:51], s24 offset:0x8e3c
    s_buffer_load_dwordx2 s[100:101], s[48:51], s24 offset:0x8f3c
    s_buffer_load_dwordx2 s[100:101], s[48:51], s24 offset:0x903c
    s_buffer_load_dwordx2 s[100:101], s[48:51], s24 offset:0x913c
    s_buffer_load_dwordx2 s[100:101], s[48:51], s24 offset:0x923c
    s_waitcnt lgkmcnt(0)
    s_lshr_b32 s24, s2, 3
    s_mul_i32 s24, s24, 44032
    s_lshl_b32 s27, s35, 7
    s_add_u32 s24, s24, s27
    s_buffer_load_dwordx2 s[100:101], s[48:51], s24 offset:0x9a3c
    s_buffer_load_dwordx2 s[100:101], s[48:51], s24 offset:0x9b3c
    s_buffer_load_dwordx2 s[100:101], s[48:51], s24 offset:0x9c3c
    s_buffer_load_dwordx2 s[100:101], s[48:51], s24 offset:0x9d3c
    s_buffer_load_dwordx2 s[100:101], s[48:51], s24 offset:0x9e3c
    s_buffer_load_dwordx2 s[100:101], s[48:51], s24 offset:0x9f3c
    s_buffer_load_dwordx2 s[100:101], s[48:51], s24 offset:0xa03c
    s_and_b32 s30, s2, 7
    s_lshr_b32 s31, s2, 3
    s_lshl_b32 s21, s30, 1
    s_and_b32 s22, s31, 1
    s_add_u32 s33, s21, s22
    s_lshr_b32 s34, s31, 1
    s_lshl_b32 s21, s33, 7
    s_min_u32 s22, s34, 14
    s_mul_i32 s22, s22, 192
    s_mul_i32 s31, s35, 64
    s_add_u32 s31, s31, s21
    s_lshl_b32 s31, s31, 12
    v_add_u32 v7, s31, v6
    s_and_b32 s36, s2, 7
    s_lshl_b32 s36, s36, 8
    s_lshr_b32 s31, s2, 3
    s_and_b32 s31, s31, 1
    s_lshl_b32 s31, s31, 1
    s_add_u32 s31, s31, s35
    s_lshl_b32 s31, s31, 6
    s_add_u32 s36, s36, s31
    s_add_u32 s36, s36, 0x980800
    s_barrier
    s_lshr_b32 s24, s2, 3
    s_mul_i32 s24, s24, 44032
    s_lshl_b32 s27, s35, 7
    s_add_u32 s24, s24, s27
    s_buffer_load_dwordx2 s[100:101], s[48:51], s24 offset:0xa83c
    s_buffer_load_dwordx2 s[100:101], s[48:51], s24 offset:0xa93c
    s_buffer_load_dwordx2 s[100:101], s[48:51], s24 offset:0xaa3c
    s_buffer_load_dwordx2 s[100:101], s[48:51], s24 offset:0xab3c
    s_lshr_b32 s24, s2, 3
    s_and_b32 s27, s2, 7
    s_lshl_b32 s27, s27, 5
    s_add_u32 s24, s24, s27
    s_and_b32 s27, s24, 1
    s_mul_i32 s27, s27, 13824
    s_lshr_b32 s24, s24, 1
    s_lshl_b32 s24, s24, 16
    s_add_u32 s24, s24, s27
    s_add_u32 s24, s24, 16384
    s_lshl_b32 s27, s35, 7
    s_add_u32 s24, s24, s27
    s_buffer_load_dwordx2 s[100:101], s[16:19], s24 offset:0x3c
    s_buffer_load_dwordx2 s[100:101], s[16:19], s24 offset:0x13c
    s_buffer_load_dwordx2 s[100:101], s[16:19], s24 offset:0x23c
    s_mov_b64 exec, 0xffff
    s_mov_b32 s28, 16384
Lp49:
    buffer_load_dword v22, v23, s[16:19], s36 offen sc1
    s_sub_u32 s28, s28, 1
    s_cbranch_scc1 Lok50
    s_waitcnt vmcnt(0)
    v_cmp_ne_u32 vcc, 0x01010101, v22
    s_cbranch_vccnz Lp49
Lok50:
    s_waitcnt vmcnt(0)
    s_mov_b64 exec, -1
    s_add_u32 m0, s32, 0x12000
    s_mov_b32 s30, 0xac00
    buffer_load_dwordx4 v7, s[16:19], s30 offen sc1 lds
    s_add_u32 m0, s32, 0x12400
    s_mov_b32 s30, 0x1ac00
    buffer_load_dwordx4 v7, s[16:19], s30 offen sc1 lds
    s_add_u32 m0, s32, 0x12800
    s_mov_b32 s30, 0x2ac00
    buffer_load_dwordx4 v7, s[16:19], s30 offen sc1 lds
    s_add_u32 m0, s32, 0x12c00
    s_mov_b32 s30, 0x3ac00
    buffer_load_dwordx4 v7, s[16:19], s30 offen sc1 lds
    s_add_u32 m0, s32, 0x14000
    s_mov_b32 s30, 0xb000
    buffer_load_dwordx4 v7, s[16:19], s30 offen sc1 lds
    s_add_u32 m0, s32, 0x14400
    s_mov_b32 s30, 0x1b000
    buffer_load_dwordx4 v7, s[16:19], s30 offen sc1 lds
    s_add_u32 m0, s32, 0x14800
    s_mov_b32 s30, 0x2b000
    buffer_load_dwordx4 v7, s[16:19], s30 offen sc1 lds
    s_add_u32 m0, s32, 0x14c00
    s_mov_b32 s30, 0x3b000
    buffer_load_dwordx4 v7, s[16:19], s30 offen sc1 lds
    s_add_u32 m0, s32, 0x16000
    s_mov_b32 s30, 0xb400
    buffer_load_dwordx4 v7, s[16:19], s30 offen sc1 lds
    s_add_u32 m0, s32, 0x16400
    s_mov_b32 s30, 0x1b400
    buffer_load_dwordx4 v7, s[16:19], s30 offen sc1 lds
    s_add_u32 m0, s32, 0x16800
    s_mov_b32 s30, 0x2b400
    buffer_load_dwordx4 v7, s[16:19], s30 offen sc1 lds
    s_add_u32 m0, s32, 0x16c00
    s_mov_b32 s30, 0x3b400
    buffer_load_dwordx4 v7, s[16:19], s30 offen sc1 lds
    s_add_u32 m0, s32, 0x18000
    s_mov_b32 s30, 0xb800
    buffer_load_dwordx4 v7, s[16:19], s30 offen sc1 lds
    s_add_u32 m0, s32, 0x18400
    s_mov_b32 s30, 0x1b800
    buffer_load_dwordx4 v7, s[16:19], s30 offen sc1 lds
    s_add_u32 m0, s32, 0x18800
    s_mov_b32 s30, 0x2b800
    buffer_load_dwordx4 v7, s[16:19], s30 offen sc1 lds
    s_add_u32 m0, s32, 0x18c00
    s_mov_b32 s30, 0x3b800
    buffer_load_dwordx4 v7, s[16:19], s30 offen sc1 lds
    s_add_u32 m0, s32, 0x1a000
    s_mov_b32 s30, 0xbc00
    buffer_load_dwordx4 v7, s[16:19], s30 offen sc1 lds
    s_add_u32 m0, s32, 0x1a400
    s_mov_b32 s30, 0x1bc00
    buffer_load_dwordx4 v7, s[16:19], s30 offen sc1 lds
    s_add_u32 m0, s32, 0x1a800
    s_mov_b32 s30, 0x2bc00
    buffer_load_dwordx4 v7, s[16:19], s30 offen sc1 lds
    s_add_u32 m0, s32, 0x1ac00
    s_mov_b32 s30, 0x3bc00
    buffer_load_dwordx4 v7, s[16:19], s30 offen sc1 lds
    s_add_u32 m0, s32, 0x1c000
    s_mov_b32 s30, 0xc000
    buffer_load_dwordx4 v7, s[16:19], s30 offen sc1 lds
    s_add_u32 m0, s32, 0x1c400
    s_mov_b32 s30, 0x1c000
    buffer_load_dwordx4 v7, s[16:19], s30 offen sc1 lds
    s_add_u32 m0, s32, 0x1c800
    s_mov_b32 s30, 0x2c000
    buffer_load_dwordx4 v7, s[16:19], s30 offen sc1 lds
    s_add_u32 m0, s32, 0x1cc00
    s_mov_b32 s30, 0x3c000
    buffer_load_dwordx4 v7, s[16:19], s30 offen sc1 lds
    s_add_u32 m0, s32, 0x1e000
    s_mov_b32 s30, 0xc400
    buffer_load_dwordx4 v7, s[16:19], s30 offen sc1 lds
    s_add_u32 m0, s32, 0x1e400
    s_mov_b32 s30, 0x1c400
    buffer_load_dwordx4 v7, s[16:19], s30 offen sc1 lds
    s_add_u32 m0, s32, 0x1e800
    s_mov_b32 s30, 0x2c400
    buffer_load_dwordx4 v7, s[16:19], s30 offen sc1 lds
    s_add_u32 m0, s32, 0x1ec00
    s_mov_b32 s30, 0x3c400
    buffer_load_dwordx4 v7, s[16:19], s30 offen sc1 lds
    s_add_u32 m0, s32, 0x20000
    s_mov_b32 s30, 0xc800
    buffer_load_dwordx4 v7, s[16:19], s30 offen sc1 lds
    s_add_u32 m0, s32, 0x20400
    s_mov_b32 s30, 0x1c800
    buffer_load_dwordx4 v7, s[16:19], s30 offen sc1 lds
    s_add_u32 m0, s32, 0x20800
    s_mov_b32 s30, 0x2c800
    buffer_load_dwordx4 v7, s[16:19], s30 offen sc1 lds
    s_add_u32 m0, s32, 0x20c00
    s_mov_b32 s30, 0x3c800
    buffer_load_dwordx4 v7, s[16:19], s30 offen sc1 lds
    s_waitcnt vmcnt(28)
    s_barrier
    s_lshr_b32 s24, s2, 3
    s_and_b32 s27, s2, 7
    s_lshl_b32 s27, s27, 5
    s_add_u32 s24, s24, s27
    s_and_b32 s27, s24, 1
    s_mul_i32 s27, s27, 13824
    s_lshr_b32 s24, s24, 1
    s_lshl_b32 s24, s24, 16
    s_add_u32 s24, s24, s27
    s_add_u32 s24, s24, 16384
    s_lshl_b32 s27, s35, 7
    s_add_u32 s24, s24, s27
    s_buffer_load_dwordx2 s[100:101], s[16:19], s24 offset:0xa3c
    s_buffer_load_dwordx2 s[100:101], s[16:19], s24 offset:0xb3c
    s_buffer_load_dwordx2 s[100:101], s[16:19], s24 offset:0xc3c
    s_buffer_load_dwordx2 s[100:101], s[16:19], s24 offset:0xd3c
    s_buffer_load_dwordx2 s[100:101], s[16:19], s24 offset:0xe3c
    s_buffer_load_dwordx2 s[100:101], s[16:19], s24 offset:0xf3c
    s_buffer_load_dwordx2 s[100:101], s[16:19], s24 offset:0x103c
    s_waitcnt vmcnt(24)
    s_barrier
    s_waitcnt vmcnt(16)
    s_barrier
    s_add_u32 m0, s32, 0x12000
    s_mov_b32 s30, 0xcc00
    buffer_load_dwordx4 v7, s[16:19], s30 offen sc1 lds
    s_add_u32 m0, s32, 0x12400
    s_mov_b32 s30, 0x1cc00
    buffer_load_dwordx4 v7, s[16:19], s30 offen sc1 lds
    s_add_u32 m0, s32, 0x12800
    s_mov_b32 s30, 0x2cc00
    buffer_load_dwordx4 v7, s[16:19], s30 offen sc1 lds
    s_add_u32 m0, s32, 0x12c00
    s_mov_b32 s30, 0x3cc00
    buffer_load_dwordx4 v7, s[16:19], s30 offen sc1 lds
    s_waitcnt vmcnt(12)
    s_barrier
    s_add_u32 m0, s32, 0x14000
    s_mov_b32 s30, 0xd000
    buffer_load_dwordx4 v7, s[16:19], s30 offen sc1 lds
    s_add_u32 m0, s32, 0x14400
    s_mov_b32 s30, 0x1d000
    buffer_load_dwordx4 v7, s[16:19], s30 offen sc1 lds
    s_add_u32 m0, s32, 0x14800
    s_mov_b32 s30, 0x2d000
    buffer_load_dwordx4 v7, s[16:19], s30 offen sc1 lds
    s_add_u32 m0, s32, 0x14c00
    s_mov_b32 s30, 0x3d000
    buffer_load_dwordx4 v7, s[16:19], s30 offen sc1 lds
    s_add_u32 m0, s32, 0x16000
    s_mov_b32 s30, 0xd400
    buffer_load_dwordx4 v7, s[16:19], s30 offen sc1 lds
    s_add_u32 m0, s32, 0x16400
    s_mov_b32 s30, 0x1d400
    buffer_load_dwordx4 v7, s[16:19], s30 offen sc1 lds
    s_add_u32 m0, s32, 0x16800
    s_mov_b32 s30, 0x2d400
    buffer_load_dwordx4 v7, s[16:19], s30 offen sc1 lds
    s_add_u32 m0, s32, 0x16c00
    s_mov_b32 s30, 0x3d400
    buffer_load_dwordx4 v7, s[16:19], s30 offen sc1 lds
    s_waitcnt vmcnt(12)
    s_barrier
    s_add_u32 m0, s32, 0x18000
    s_mov_b32 s30, 0xd800
    buffer_load_dwordx4 v7, s[16:19], s30 offen sc1 lds
    s_add_u32 m0, s32, 0x18400
    s_mov_b32 s30, 0x1d800
    buffer_load_dwordx4 v7, s[16:19], s30 offen sc1 lds
    s_add_u32 m0, s32, 0x18800
    s_mov_b32 s30, 0x2d800
    buffer_load_dwordx4 v7, s[16:19], s30 offen sc1 lds
    s_add_u32 m0, s32, 0x18c00
    s_mov_b32 s30, 0x3d800
    buffer_load_dwordx4 v7, s[16:19], s30 offen sc1 lds
    s_add_u32 m0, s32, 0x1a000
    s_mov_b32 s30, 0xdc00
    buffer_load_dwordx4 v7, s[16:19], s30 offen sc1 lds
    s_add_u32 m0, s32, 0x1a400
    s_mov_b32 s30, 0x1dc00
    buffer_load_dwordx4 v7, s[16:19], s30 offen sc1 lds
    s_add_u32 m0, s32, 0x1a800
    s_mov_b32 s30, 0x2dc00
    buffer_load_dwordx4 v7, s[16:19], s30 offen sc1 lds
    s_add_u32 m0, s32, 0x1ac00
    s_mov_b32 s30, 0x3dc00
    buffer_load_dwordx4 v7, s[16:19], s30 offen sc1 lds
    s_lshr_b32 s24, s2, 3
    s_and_b32 s27, s2, 7
    s_lshl_b32 s27, s27, 5
    s_add_u32 s24, s24, s27
    s_and_b32 s27, s24, 1
    s_mul_i32 s27, s27, 13824
    s_lshr_b32 s24, s24, 1
    s_lshl_b32 s24, s24, 16
    s_add_u32 s24, s24, s27
    s_add_u32 s24, s24, 16384
    s_lshl_b32 s27, s35, 7
    s_add_u32 s24, s24, s27
    s_buffer_load_dwordx2 s[100:101], s[16:19], s24 offset:0x183c
    s_buffer_load_dwordx2 s[100:101], s[16:19], s24 offset:0x193c
    s_buffer_load_dwordx2 s[100:101], s[16:19], s24 offset:0x1a3c
    s_buffer_load_dwordx2 s[100:101], s[16:19], s24 offset:0x1b3c
    s_buffer_load_dwordx2 s[100:101], s[16:19], s24 offset:0x1c3c
    s_buffer_load_dwordx2 s[100:101], s[16:19], s24 offset:0x1d3c
    s_buffer_load_dwordx2 s[100:101], s[16:19], s24 offset:0x1e3c
    s_waitcnt vmcnt(12)
    s_barrier
    s_add_u32 m0, s32, 0x1c000
    s_mov_b32 s30, 0xe000
    buffer_load_dwordx4 v7, s[16:19], s30 offen sc1 lds
    s_add_u32 m0, s32, 0x1c400
    s_mov_b32 s30, 0x1e000
    buffer_load_dwordx4 v7, s[16:19], s30 offen sc1 lds
    s_add_u32 m0, s32, 0x1c800
    s_mov_b32 s30, 0x2e000
    buffer_load_dwordx4 v7, s[16:19], s30 offen sc1 lds
    s_add_u32 m0, s32, 0x1cc00
    s_mov_b32 s30, 0x3e000
    buffer_load_dwordx4 v7, s[16:19], s30 offen sc1 lds
    s_add_u32 m0, s32, 0x1e000
    s_mov_b32 s30, 0xe400
    buffer_load_dwordx4 v7, s[16:19], s30 offen sc1 lds
    s_add_u32 m0, s32, 0x1e400
    s_mov_b32 s30, 0x1e400
    buffer_load_dwordx4 v7, s[16:19], s30 offen sc1 lds
    s_add_u32 m0, s32, 0x1e800
    s_mov_b32 s30, 0x2e400
    buffer_load_dwordx4 v7, s[16:19], s30 offen sc1 lds
    s_add_u32 m0, s32, 0x1ec00
    s_mov_b32 s30, 0x3e400
    buffer_load_dwordx4 v7, s[16:19], s30 offen sc1 lds
    s_waitcnt vmcnt(12)
    s_barrier
    s_add_u32 m0, s32, 0x20000
    s_mov_b32 s30, 0xe800
    buffer_load_dwordx4 v7, s[16:19], s30 offen sc1 lds
    s_add_u32 m0, s32, 0x20400
    s_mov_b32 s30, 0x1e800
    buffer_load_dwordx4 v7, s[16:19], s30 offen sc1 lds
    s_add_u32 m0, s32, 0x20800
    s_mov_b32 s30, 0x2e800
    buffer_load_dwordx4 v7, s[16:19], s30 offen sc1 lds
    s_add_u32 m0, s32, 0x20c00
    s_mov_b32 s30, 0x3e800
    buffer_load_dwordx4 v7, s[16:19], s30 offen sc1 lds
    s_waitcnt vmcnt(8)
    s_barrier
    s_waitcnt vmcnt(0)
    s_barrier
    s_endpgm
mega_end:
.section .rodata,"a"
.p2align 6
.amdhsa_kernel mega_kernel
  .amdhsa_next_free_vgpr 168
  .amdhsa_next_free_sgpr 102
  .amdhsa_accum_offset 168
  .amdhsa_group_segment_fixed_size 0
  .amdhsa_kernarg_size 96
  .amdhsa_user_sgpr_count 2
  .amdhsa_user_sgpr_kernarg_segment_ptr 1
  .amdhsa_system_sgpr_workgroup_id_x 1
.end_amdhsa_kernel
```
